```python
import torch

def _softmax(x, axis=-1):
    return torch.softmax(x, dim=axis)
def _gelu(x):
    return torch.nn.functional.gelu(x, approximate="tanh")
def _silu(x):
    return torch.nn.functional.silu(x)
def _sigmoid(x):
    return torch.sigmoid(x)
def _layernorm(x, axis=-1, eps=1e-5):
    m = x.mean(dim=axis, keepdim=True)
    v = x.var(dim=axis, keepdim=True, unbiased=False)
    return (x - m) / torch.sqrt(v + eps)
def _scatter_add(tgt, idx, src, axis=0):
    return tgt.clone().index_add_(axis, idx, src)
def _segment_sum(src, seg, n):
    out = torch.zeros((n,) + src.shape[1:], dtype=src.dtype)
    return out.index_add_(0, seg, src)
def _pad(x, pw):
    flat = tuple(v for pair in reversed(pw) for v in pair)
    return torch.nn.functional.pad(x, flat)

kernel_name = 'recurrent_scan__ssm_conv_s4__moe_arch_mod__prompt'

def setup_inputs():

    _w = (lambda a: (lambda t: t.to(torch.bfloat16) if t.is_floating_point() else t)(torch.as_tensor(a)))
    def _A_setup():
        B, L, D, N = 1, 2048, 512, 128
        A_re = -(lambda _x: torch.exp(torch.as_tensor(_x)))((lambda *s: torch.randn(*s, dtype=torch.bfloat16) * 6.4)(D, N))
        A_im = torch.pi * (lambda *s: torch.randn(*s, dtype=torch.bfloat16) * 0.05)(D, N)
        B_re = (lambda *s: torch.randn(*s, dtype=torch.bfloat16) * 0.1)(D, N)
        B_im = (lambda *s: torch.randn(*s, dtype=torch.bfloat16) * 0.1)(D, N)
        C_re = (lambda *s: torch.randn(*s, dtype=torch.bfloat16) * 0.1)(D, N)
        C_im = (lambda *s: torch.randn(*s, dtype=torch.bfloat16) * 0.1)(D, N)
        log_dt = (lambda *s: torch.randn(*s, dtype=torch.bfloat16) * 0.05)(D) * 0.5 - 4.0
        Dskip = (lambda *s: torch.randn(*s, dtype=torch.bfloat16) * 0.05)(D)
        return {
            "u": _w((lambda *s: torch.randn(*s, dtype=torch.bfloat16) * 0.05)(B, L, D)),
            "A_re": _w(A_re),
            "A_im": _w(A_im),
            "B_re": _w(B_re),
            "B_im": _w(B_im),
            "C_re": _w(C_re),
            "C_im": _w(C_im),
            "log_dt": _w(log_dt),
            "Dskip": _w(Dskip),
        }
    _A_in = _A_setup()

    def _B_setup():
        B, S, D, F, C = 1, 2048, 512, 1376, 1
        return {
            "x": _w((lambda *s: torch.randn(*s, dtype=torch.bfloat16) * 0.05)(B, S, D)),
            "w_r": _w((lambda *s: torch.randn(*s, dtype=torch.bfloat16) * 6.4)(D)),
            "w_gate": _w((lambda *s: torch.randn(*s, dtype=torch.bfloat16) * 0.1)(D, F)),
            "w_up": _w((lambda *s: torch.randn(*s, dtype=torch.bfloat16) * 0.1)(D, F)),
            "w_down": _w((lambda *s: torch.randn(*s, dtype=torch.bfloat16) * 0.1)(F, D)),
        }
    _B_in = _B_setup()

    return {
        "A_u": _A_in["u"],
        "A_A_re": _A_in["A_re"],
        "A_A_im": _A_in["A_im"],
        "A_B_re": _A_in["B_re"],
        "A_B_im": _A_in["B_im"],
        "A_C_re": _A_in["C_re"],
        "A_C_im": _A_in["C_im"],
        "A_log_dt": _A_in["log_dt"],
        "A_Dskip": _A_in["Dskip"],
        "B_x": _B_in["x"],
        "B_w_r": _B_in["w_r"],
        "B_w_gate": _B_in["w_gate"],
        "B_w_up": _B_in["w_up"],
        "B_w_down": _B_in["w_down"],
    }

def reference(A_u, A_A_re, A_A_im, A_B_re, A_B_im, A_C_re, A_C_im, A_log_dt, A_Dskip, B_x, B_w_r, B_w_gate, B_w_up, B_w_down):
    def _A_ref(u, A_re, A_im, B_re, B_im, C_re, C_im, log_dt, Dskip):
        Bsz, L, D = u.shape
        dt = torch.exp(log_dt)[:, None]
        A = A_re + 1j * A_im
        Bc = B_re + 1j * B_im
        Cc = C_re + 1j * C_im
        logdA = dt * A
        dB = dt * Bc
        l = (lambda x, dt: x.to(dt))(torch.arange(L), A_re.dtype)
        P = torch.exp(logdA[:, :, None] * l[None, None, :])
        K = torch.einsum("dn,dnl,dn->dl", Cc, P, dB).real
        L2 = 2 * L
        Kp = _pad(K, ((0, 0), (0, L)))
        up = (lambda x, *d: x.permute(*d))(u, 0, 2, 1)
        up = _pad(up, ((0, 0), (0, 0), (0, L)))
        Kf = (lambda x, axes=(-2,-1): torch.fft.rfft2(x.float(), dim=axes))(Kp[:, None, :], axes=(-2, -1))
        Uf = (lambda x, axes=(-2,-1): torch.fft.rfft2(x.float(), dim=axes))(up[:, :, None, :], axes=(-2, -1))
        Yf = Uf * Kf[None, :, :, :]
        y = (lambda x, s, axes=(-2,-1): torch.fft.irfft2(x, s=s, dim=axes).to(torch.bfloat16))(Yf, (1, L2), axes=(-2, -1))[:, :, 0, :L]
        y = (lambda x, *d: x.permute(*d))(y, 0, 2, 1) + u * Dskip[None, None, :]
        return y

    def _B_ref(x, w_r, w_gate, w_up, w_down):
        B, S, D = x.shape
        C = 1
        r = x @ w_r
        idx = torch.argsort(-r, axis=-1)[:, :C]
        idx_e = (lambda x, n, axis: torch.repeat_interleave(x, n, dim=axis))(idx.reshape(B, C, 1), D, axis=2)
        x_sel = (lambda x, i, axis: torch.take_along_dim(x, i, dim=axis))(x, idx_e, axis=1)
        g = _silu(x_sel @ w_gate)
        u = x_sel @ w_up
        y = (g * u) @ w_down
        r_sel = _sigmoid((lambda x, i, axis: torch.take_along_dim(x, i, dim=axis))(r, idx, axis=1))
        y = y * r_sel.reshape(B, C, 1)
        b_off = (torch.arange(B) * S).reshape(B, 1)
        flat_idx = (idx + b_off).reshape(B * C)
        zero = (x * 0.0).reshape(B * S, D)
        upd = _scatter_add(zero, flat_idx, y.reshape(B * C, D), axis=0)
        return x + upd.reshape(B, S, D)

    x = A_u
    xn = _layernorm(x, axis=-1)
    s = _A_ref(xn, A_A_re, A_A_im, A_B_re, A_B_im, A_C_re, A_C_im, A_log_dt, A_Dskip)
    g = _silu(_B_ref(xn, B_w_r, B_w_gate, B_w_up, B_w_down))
    return x + s * g
```

```asm
; @launch grid=(256,1,1) block=(512,1,1) lds=144640
.amdgcn_target "amdgcn-amd-amdhsa--gfx950"
.text
.globl recurrent_scan__ssm_conv_s4__moe_arch_mod__prompt_kernel
.p2align 8
.type recurrent_scan__ssm_conv_s4__moe_arch_mod__prompt_kernel,@function
recurrent_scan__ssm_conv_s4__moe_arch_mod__prompt_kernel:
    s_cmp_ge_u32 s2, 256
    s_cbranch_scc1 L_end
    s_load_dwordx16 s[4:19], s[0:1], 0
    s_load_dwordx16 s[20:35], s[0:1], 64
    s_load_dwordx2 s[36:37], s[0:1], 128
    s_getpc_b64 s[66:67]
    s_lshr_b32 s40, s2, 3
    s_mul_i32 s58, s40, 512
    v_lshl_add_u32 v239, v0, 7, s58
    v_min_u32 v239, L_end - L_cpf, v239
    v_cmp_gt_u32 vcc, 4, v0
    s_nop 0
    s_and_saveexec_b64 s[64:65], vcc
    s_cbranch_execz L_cpf
    global_load_dword v239, v239, s[66:67]
L_cpf:
    s_mov_b64 exec, -1
    v_lshrrev_b32 v240, 6, v0
    v_and_b32 v1, 63, v0
    v_readfirstlane_b32 s38, v240
    s_and_b32 s39, s2, 7
    s_and_b32 s45, s38, 3
    s_lshl_b32 s41, s39, 6
    s_lshl_b32 s61, s40, 1
    s_add_u32 s41, s41, s61
    s_cmp_lt_u32 s38, 4
    s_cbranch_scc1 L_conv
    s_lshl_b32 s58, s2, 13
    s_lshl_b32 s61, s45, 11
    s_add_u32 s58, s58, s61
    v_and_b32 v243, 31, v1
    v_lshrrev_b32 v244, 5, v1
    v_lshlrev_b32 v242, 4, v243
    v_lshl_add_u32 v243, v244, 10, v242
    v_add_u32 v243, s58, v243
    v_mov_b32 v245, 0
    s_waitcnt lgkmcnt(0)
    global_load_dwordx4 v[40:43], v243, s[4:5]
    global_load_dwordx4 v[44:47], v243, s[4:5] offset:512
    s_mov_b64 exec, 1
    global_load_dword v35, v245, s[36:37] sc1
    s_mov_b64 exec, -1
    s_barrier
    global_load_dwordx4 v[56:59], v242, s[24:25]
    global_load_dwordx4 v[60:63], v242, s[24:25] offset:512
    s_branch L_helper
L_conv:
    s_and_b32 s57, s38, 1
    s_lshr_b32 s60, s38, 1
    s_cmp_eq_u32 s60, 0
    s_cselect_b32 s63, 0, 1
    s_add_u32 s59, s41, s57
    s_lshl_b32 s58, s59, 8
    s_lshl_b32 s61, s60, 7
    s_add_u32 s58, s58, s61
    v_mov_b32 v72, 0
    v_mov_b32 v73, 0
    v_mov_b32 v74, 0
    v_mov_b32 v75, 0
    v_mov_b32 v76, 0
    v_mov_b32 v77, 0
    v_mov_b32 v78, 0
    v_lshl_add_u32 v241, v1, 1, s58
    s_lshl_b32 s59, s59, 1
    v_mov_b32 v242, s59
    s_lshl_b32 s58, s40, 16
    s_lshl_b32 s61, s45, 14
    s_add_u32 s58, s58, s61
    s_lshl_b32 s61, s39, 7
    s_add_u32 s58, s58, s61
    v_lshrrev_b32 v246, 3, v1
    v_and_b32 v247, 7, v1
    v_lshl_add_u32 v247, v247, 4, s58
    v_lshl_add_u32 v42, v246, 10, v247
    v_add_u32 v43, 8192, v42
    s_waitcnt lgkmcnt(0)
    global_load_dwordx4 v[56:59], v42, s[4:5]
    global_load_dwordx4 v[60:63], v43, s[4:5]
    s_barrier
    v_mov_b32 v246, 0
    v_mov_b32 v247, 0x3f80
    s_lshl_b32 s58, s38, 8
    v_and_b32 v248, 127, v0
    s_mov_b32 m0, s58
    v_min_u32 v248, 119, v248
    ds_write_addtid_b32 v247 offset:0
    s_mul_i32 s58, s63, 4576
    s_add_u32 s58, s58, 92288
    v_lshl_add_u32 v248, v248, 2, s58
    ds_write_b32 v248, v246
    s_mul_i32 s58, s57, 18560
    s_add_u32 s58, s58, 55168
    s_mul_i32 s59, s57, 1552
    s_add_u32 s59, s59, 101440
    s_cmp_eq_u32 s63, 0
    s_cselect_b32 s58, s58, s59
    s_cselect_b32 s59, 31, 1
    v_min_u32 v248, s59, v1
    v_lshl_add_u32 v248, v248, 2, s58
    s_mov_b32 exec_hi, 0
    ds_write_b32 v248, v246
    v_min_u32 v248, 10, v1
    v_lshlrev_b32 v248, 2, v248
    v_add_u32 v248, 135296, v248
    s_mov_b32 exec_lo, 0x7ff
    ds_write_b32 v248, v246
    s_mov_b64 exec, -1
    s_mov_b32 s55, 0xffff0000
    s_getreg_b32 s42, hwreg(HW_REG_XCC_ID, 0, 4)
    global_load_short_d16_hi v78, v242, s[18:19]
    global_load_short_d16_hi v72, v241, s[6:7]
    global_load_short_d16_hi v73, v241, s[8:9]
    global_load_short_d16_hi v74, v241, s[10:11]
    global_load_short_d16_hi v75, v241, s[12:13]
    global_load_short_d16_hi v76, v241, s[14:15]
    global_load_short_d16_hi v77, v241, s[16:17]
    s_waitcnt lgkmcnt(0)
    s_barrier
    s_lshl_b32 s58, s45, 11
    s_add_u32 s58, s58, 127104
    s_lshl_b32 s59, s39, 18
    s_lshl_b32 s61, s40, 8
    s_add_u32 s59, s59, s61
    s_lshl_b32 s61, s45, 6
    s_add_u32 s59, s59, s61
    s_add_u32 s59, s59, 1048576
    v_lshrrev_b32 v240, 3, v1
    v_and_b32 v241, 7, v1
    v_lshrrev_b32 v242, 5, v1
    v_lshlrev_b32 v242, 1, v242
    v_xor_b32 v242, v242, v241
    v_lshl_add_u32 v242, v242, 4, s58
    v_lshl_add_u32 v40, v240, 7, v242
    v_xor_b32 v41, 64, v40
    v_and_b32 v240, 3, v1
    v_lshrrev_b32 v241, 4, v1
    v_lshlrev_b32 v242, 1, v240
    v_xor_b32 v241, v241, v242
    v_lshl_add_u32 v241, v241, 4, s58
    v_lshl_add_u32 v241, v240, 9, v241
    v_bfe_u32 v242, v1, 2, 2
    v_lshl_add_u32 v38, v242, 2, v241
    v_xor_b32 v39, 64, v38
    v_lshl_add_u32 v240, v240, 4, s59
    v_lshrrev_b32 v241, 2, v1
    v_lshl_add_u32 v36, v241, 13, v240
    v_add_u32 v37, 0x20000, v36
    s_lshl_b32 s60, s39, 18
    s_lshl_b32 s61, s40, 13
    s_add_u32 s60, s60, s61
    s_lshl_b32 s61, s45, 11
    s_add_u32 s60, s60, s61
    s_add_u32 s60, s60, 1048576
    v_and_b32 v245, 15, v1
    v_lshl_add_u32 v46, v245, 7, s60
    s_mov_b64 exec, 0xffff
    global_load_dword v239, v46, s[36:37] nt
    s_mov_b64 exec, -1
    s_mul_i32 s59, s57, 3072
    s_add_u32 s59, s59, 104544
    s_mul_i32 s60, s57, 1552
    s_add_u32 s60, s60, 101448
    v_and_b32 v240, 31, v1
    v_lshrrev_b32 v241, 5, v1
    s_lshl_b32 s58, s38, 8
    v_lshl_add_u32 v242, v241, 4, s58
    s_movk_i32 s58, 1040
    v_mad_u32_u24 v25, v240, s58, v242
    v_add_u32 v243, -16, v240
    v_cmp_lt_u32 vcc, 20, v240
    v_lshl_add_u32 v26, v1, 4, s59
    s_nop 0
    v_cndmask_b32 v243, v240, v243, vcc
    v_mad_u32_u24 v24, v243, s58, v242
    v_add_u32 v24, 33280, v24
    v_lshl_add_u32 v242, v241, 3, s60
    v_lshl_add_u32 v31, v240, 4, v242
    v_sub_u32 v242, 3, v241
    v_lshlrev_b32 v242, v242, v240
    v_lshl_add_u32 v243, v241, 8, s60
    v_add_u32 v243, 512, v243
    v_add_u32 v32, v242, v243
    v_mul_u32_u24 v242, 124, v241
    v_add3_u32 v33, v32, v242, 4
    v_lshl_add_u32 v34, v240, 1, v243
    v_add_u32 v34, 512, v34
    s_lshl_b32 s58, s57, 2
    s_add_u32 s58, s58, 135320
    v_mov_b32 v35, s58
    v_lshlrev_b32 v240, 2, v0
    s_cmp_eq_u32 s38, 0
    s_cbranch_scc1 L_pos0a
    v_add_u32 v64, -3, v240
    v_add_u32 v65, -2, v240
    v_add_u32 v66, -1, v240
    v_add_u32 v67, 0, v240
    v_add_u32 v68, 1, v240
    v_add_u32 v69, 2, v240
    v_add_u32 v70, 3, v240
    v_cvt_f32_u32 v64, v64
    v_cvt_f32_u32 v65, v65
    v_cvt_f32_u32 v66, v66
    v_cvt_f32_u32 v67, v67
    v_cvt_f32_u32 v68, v68
    v_cvt_f32_u32 v69, v69
    v_cvt_f32_u32 v70, v70
    v_cvt_pk_bf16_f32 v248, v64, v65
    v_cvt_pk_bf16_f32 v249, v66, v67
    v_cvt_pk_bf16_f32 v250, v68, v69
    v_cvt_pk_bf16_f32 v251, v70, v70
    v_mov_b32 v241, -17020
    v_bfe_u32 v64, v248, 0, 16
    v_add_u32 v64, v241, v64
    v_bfe_u32 v65, v248, 16, 16
    v_add_u32 v65, v241, v65
    v_bfe_u32 v66, v249, 0, 16
    v_add_u32 v66, v241, v66
    v_bfe_u32 v67, v249, 16, 16
    v_add_u32 v67, v241, v67
    v_bfe_u32 v68, v250, 0, 16
    v_add_u32 v68, v241, v68
    v_bfe_u32 v69, v250, 16, 16
    v_add_u32 v69, v241, v69
    v_bfe_u32 v70, v251, 0, 16
    v_add_u32 v70, v241, v70
    s_branch L_pos_donea
L_pos0a:
    v_add_u32 v64, 1, v240
    v_add_u32 v65, 2, v240
    v_add_u32 v66, 3, v240
    v_add_u32 v67, 4, v240
    v_add_u32 v68, 5, v240
    v_add_u32 v69, 6, v240
    v_add_u32 v70, 7, v240
L_pos_donea:
    v_and_b32 v241, -2, v66
    v_add_u32 v241, -2, v241
    v_and_b32 v242, -2, v67
    v_add_u32 v243, v241, v241
    v_add_u32 v244, v242, v242
    v_add_u32 v2, 101440, v243
    v_add_u32 v3, 101440, v244
    v_add_u32 v4, 102992, v243
    v_add_u32 v5, 102992, v244
    v_sub_u32 v64, v64, v241
    v_sub_u32 v65, v65, v241
    v_sub_u32 v66, v66, v241
    v_sub_u32 v67, v67, v242
    v_sub_u32 v68, v68, v242
    v_sub_u32 v69, v69, v242
    v_sub_u32 v70, v70, v242
    s_movk_i32 s58, 0x0202
    v_mov_b32 v243, 0x0100
    v_mad_u32_u24 v64, v64, s58, v243
    v_mad_u32_u24 v65, v65, s58, v243
    v_mad_u32_u24 v66, v66, s58, v243
    v_mad_u32_u24 v67, v67, s58, v243
    v_mad_u32_u24 v68, v68, s58, v243
    v_mad_u32_u24 v69, v69, s58, v243
    v_mad_u32_u24 v70, v70, s58, v243
    v_lshl_or_b32 v10, v64, 16, v65
    v_lshl_or_b32 v11, v65, 16, v66
    v_lshl_or_b32 v12, v66, 16, v67
    v_lshl_or_b32 v13, v67, 16, v68
    v_lshl_or_b32 v14, v68, 16, v69
    v_lshl_or_b32 v15, v69, 16, v70
    v_add_u32 v12, 0xfbfc0404, v12
    v_and_b32 v240, -4, v0
    v_lshlrev_b32 v240, 2, v240
    v_lshl_add_u32 v22, v0, 5, v240
    v_add_u32 v22, 55312, v22
    s_mul_i32 s56, s39, 43
    s_lshr_b32 s56, s56, 3
    s_mul_i32 s58, s45, 96
    s_lshl_b32 s61, s56, 6
    s_add_u32 s58, s58, s61
    v_lshrrev_b32 v246, 3, v1
    v_lshl_add_u32 v246, s40, 4, v246
    v_and_b32 v247, 7, v1
    v_min_u32 v247, 5, v247
    v_lshl_add_u32 v247, v247, 4, s58
    v_min_u32 v247, 2736, v247
    s_movk_i32 s58, 2752
    v_mad_u32_u24 v47, v246, s58, v247
    v_add_u32 v71, 22016, v47
    s_waitcnt vmcnt(8)
    ds_write_b128 v40, v[56:59]
    ds_write_b128 v41, v[60:63] offset:1024
    ds_read2_b32 v[48:49], v38 offset0:0 offset1:32
    ds_read2_b32 v[50:51], v38 offset0:64 offset1:96
    ds_read2_b32 v[52:53], v39 offset0:0 offset1:32
    ds_read2_b32 v[54:55], v39 offset0:64 offset1:96
    s_waitcnt lgkmcnt(0)
    global_store_dwordx4 v36, v[48:51], s[36:37]
    global_store_dwordx4 v37, v[52:55], s[36:37]
    v_add_u32 v245, 256, v0
    v_lshlrev_b32 v240, 2, v245
    v_add_u32 v64, -3, v240
    v_add_u32 v65, -2, v240
    v_add_u32 v66, -1, v240
    v_add_u32 v67, 0, v240
    v_add_u32 v68, 1, v240
    v_add_u32 v69, 2, v240
    v_add_u32 v70, 3, v240
    v_cvt_f32_u32 v64, v64
    v_cvt_f32_u32 v65, v65
    v_cvt_f32_u32 v66, v66
    v_cvt_f32_u32 v67, v67
    v_cvt_f32_u32 v68, v68
    v_cvt_f32_u32 v69, v69
    v_cvt_f32_u32 v70, v70
    v_cvt_pk_bf16_f32 v248, v64, v65
    v_cvt_pk_bf16_f32 v249, v66, v67
    v_cvt_pk_bf16_f32 v250, v68, v69
    v_cvt_pk_bf16_f32 v251, v70, v70
    v_mov_b32 v241, -17020
    v_bfe_u32 v64, v248, 0, 16
    v_add_u32 v64, v241, v64
    v_bfe_u32 v65, v248, 16, 16
    v_add_u32 v65, v241, v65
    v_bfe_u32 v66, v249, 0, 16
    v_add_u32 v66, v241, v66
    v_bfe_u32 v67, v249, 16, 16
    v_add_u32 v67, v241, v67
    v_bfe_u32 v68, v250, 0, 16
    v_add_u32 v68, v241, v68
    v_bfe_u32 v69, v250, 16, 16
    v_add_u32 v69, v241, v69
    v_bfe_u32 v70, v251, 0, 16
    v_add_u32 v70, v241, v70
    v_and_b32 v241, -2, v66
    v_add_u32 v241, -2, v241
    v_and_b32 v242, -2, v67
    v_add_u32 v243, v241, v241
    v_add_u32 v244, v242, v242
    v_add_u32 v6, 101440, v243
    v_add_u32 v7, 101440, v244
    v_add_u32 v8, 102992, v243
    v_add_u32 v9, 102992, v244
    v_sub_u32 v64, v64, v241
    v_sub_u32 v65, v65, v241
    v_sub_u32 v66, v66, v241
    v_sub_u32 v67, v67, v242
    v_sub_u32 v68, v68, v242
    v_sub_u32 v69, v69, v242
    v_sub_u32 v70, v70, v242
    s_movk_i32 s58, 0x0202
    v_mov_b32 v243, 0x0100
    v_mad_u32_u24 v64, v64, s58, v243
    v_mad_u32_u24 v65, v65, s58, v243
    v_mad_u32_u24 v66, v66, s58, v243
    v_mad_u32_u24 v67, v67, s58, v243
    v_mad_u32_u24 v68, v68, s58, v243
    v_mad_u32_u24 v69, v69, s58, v243
    v_mad_u32_u24 v70, v70, s58, v243
    v_lshl_or_b32 v16, v64, 16, v65
    v_lshl_or_b32 v17, v65, 16, v66
    v_lshl_or_b32 v18, v66, 16, v67
    v_lshl_or_b32 v19, v67, 16, v68
    v_lshl_or_b32 v20, v68, 16, v69
    v_lshl_or_b32 v21, v69, 16, v70
    v_add_u32 v18, 0xfbfc0404, v18
    v_and_b32 v240, -4, v245
    v_lshlrev_b32 v240, 2, v240
    v_lshl_add_u32 v23, v245, 5, v240
    v_add_u32 v23, 55312, v23
    s_waitcnt vmcnt(0)
    s_barrier
    v_mov_b32 v79, 0x3fb8aa3b
    v_mul_f32 v78, v78, v79
    v_exp_f32 v78, v78
    v_mul_f32 v72, v79, v72
    v_cvt_pk_bf16_f32 v78, v78, v78
    v_mul_f32 v73, 0.15915494, v73
    v_and_b32 v78, s55, v78
    v_mul_f32 v72, v78, v72
    v_mul_f32 v73, v78, v73
    v_exp_f32 v128, v72
    v_fract_f32 v129, v73
    v_mul_f32 v72, 0x43800000, v72
    v_cos_f32 v80, v129
    global_load_dwordx4 v[144:147], v47, s[26:27]
    global_load_dwordx4 v[148:151], v71, s[26:27]
    global_load_dwordx4 v[152:155], v47, s[28:29]
    global_load_dwordx4 v[156:159], v71, s[28:29]
    v_mul_f32 v73, 0x43800000, v73
    v_sin_f32 v81, v129
    v_fract_f32 v131, v73
    v_exp_f32 v130, v72
    v_mul_f32 v80, v128, v80
    v_cos_f32 v86, v131
    v_mul_f32 v81, v128, v81
    v_sin_f32 v87, v131
    v_pk_mul_f32 v[82:83], v[80:81], v[80:81] op_sel:[1,1] op_sel_hi:[1,0]
    v_pk_fma_f32 v[82:83], v[80:81], v[80:81], v[82:83] op_sel:[0,0,0] op_sel_hi:[0,1,1] neg_lo:[0,0,1]
    v_mul_f32 v86, v130, v86
    v_mul_f32 v87, v130, v87
    v_pk_mul_f32 v[84:85], v[82:83], v[82:83] op_sel:[1,1] op_sel_hi:[1,0]
    v_pk_fma_f32 v[84:85], v[82:83], v[82:83], v[84:85] op_sel:[0,0,0] op_sel_hi:[0,1,1] neg_lo:[0,0,1]
    v_pk_mul_f32 v[88:89], v[84:85], v[84:85] op_sel:[1,1] op_sel_hi:[1,0]
    v_pk_fma_f32 v[88:89], v[84:85], v[84:85], v[88:89] op_sel:[0,0,0] op_sel_hi:[0,1,1] neg_lo:[0,0,1]
    v_pk_mul_f32 v[90:91], v[88:89], v[88:89] op_sel:[1,1] op_sel_hi:[1,0]
    v_pk_fma_f32 v[90:91], v[88:89], v[88:89], v[90:91] op_sel:[0,0,0] op_sel_hi:[0,1,1] neg_lo:[0,0,1]
    v_cvt_pk_bf16_f32 v128, v88, v89
    v_pk_mul_f32 v[118:119], v[90:91], v[88:89] op_sel:[1,1] op_sel_hi:[1,0]
    v_pk_fma_f32 v[118:119], v[90:91], v[88:89], v[118:119] op_sel:[0,0,0] op_sel_hi:[0,1,1] neg_lo:[0,0,1]
    v_cvt_pk_bf16_f32 v129, v90, v91
    v_pk_mul_f32 v[92:93], v[90:91], v[90:91] op_sel:[1,1] op_sel_hi:[1,0]
    v_pk_fma_f32 v[92:93], v[90:91], v[90:91], v[92:93] op_sel:[0,0,0] op_sel_hi:[0,1,1] neg_lo:[0,0,1]
    v_cvt_pk_bf16_f32 v130, v118, v119
    v_cvt_pk_bf16_f32 v131, v92, v93
    ds_write_addtid_b32 v128 offset:1040
    ds_write_addtid_b32 v129 offset:2080
    ds_write_addtid_b32 v130 offset:3120
    ds_write_addtid_b32 v131 offset:4160
    v_pk_mul_f32 v[122:123], v[88:89], v[92:93] op_sel:[1,1] op_sel_hi:[1,0]
    v_pk_fma_f32 v[122:123], v[88:89], v[92:93], v[122:123] op_sel:[0,0,0] op_sel_hi:[0,1,1] neg_lo:[0,0,1]
    v_cvt_pk_bf16_f32 v132, v122, v123
    v_pk_mul_f32 v[124:125], v[90:91], v[92:93] op_sel:[1,1] op_sel_hi:[1,0]
    v_pk_fma_f32 v[124:125], v[90:91], v[92:93], v[124:125] op_sel:[0,0,0] op_sel_hi:[0,1,1] neg_lo:[0,0,1]
    v_cvt_pk_bf16_f32 v133, v124, v125
    v_pk_mul_f32 v[126:127], v[118:119], v[92:93] op_sel:[1,1] op_sel_hi:[1,0]
    v_pk_fma_f32 v[126:127], v[118:119], v[92:93], v[126:127] op_sel:[0,0,0] op_sel_hi:[0,1,1] neg_lo:[0,0,1]
    v_cvt_pk_bf16_f32 v134, v126, v127
    v_pk_mul_f32 v[112:113], v[92:93], v[92:93] op_sel:[1,1] op_sel_hi:[1,0]
    v_pk_fma_f32 v[112:113], v[92:93], v[92:93], v[112:113] op_sel:[0,0,0] op_sel_hi:[0,1,1] neg_lo:[0,0,1]
    v_cvt_pk_bf16_f32 v135, v112, v113
    ds_write_addtid_b32 v132 offset:5200
    ds_write_addtid_b32 v133 offset:6240
    ds_write_addtid_b32 v134 offset:7280
    ds_write_addtid_b32 v135 offset:8320
    v_pk_mul_f32 v[114:115], v[122:123], v[92:93] op_sel:[1,1] op_sel_hi:[1,0]
    v_pk_fma_f32 v[114:115], v[122:123], v[92:93], v[114:115] op_sel:[0,0,0] op_sel_hi:[0,1,1] neg_lo:[0,0,1]
    v_cvt_pk_bf16_f32 v128, v114, v115
    v_pk_mul_f32 v[116:117], v[124:125], v[92:93] op_sel:[1,1] op_sel_hi:[1,0]
    v_pk_fma_f32 v[116:117], v[124:125], v[92:93], v[116:117] op_sel:[0,0,0] op_sel_hi:[0,1,1] neg_lo:[0,0,1]
    v_cvt_pk_bf16_f32 v129, v116, v117
    v_pk_mul_f32 v[118:119], v[126:127], v[92:93] op_sel:[1,1] op_sel_hi:[1,0]
    v_pk_fma_f32 v[118:119], v[126:127], v[92:93], v[118:119] op_sel:[0,0,0] op_sel_hi:[0,1,1] neg_lo:[0,0,1]
    v_cvt_pk_bf16_f32 v130, v118, v119
    v_pk_mul_f32 v[120:121], v[112:113], v[92:93] op_sel:[1,1] op_sel_hi:[1,0]
    v_pk_fma_f32 v[120:121], v[112:113], v[92:93], v[120:121] op_sel:[0,0,0] op_sel_hi:[0,1,1] neg_lo:[0,0,1]
    v_cvt_pk_bf16_f32 v131, v120, v121
    ds_write_addtid_b32 v128 offset:9360
    ds_write_addtid_b32 v129 offset:10400
    ds_write_addtid_b32 v130 offset:11440
    ds_write_addtid_b32 v131 offset:12480
    v_pk_mul_f32 v[122:123], v[114:115], v[92:93] op_sel:[1,1] op_sel_hi:[1,0]
    v_pk_fma_f32 v[122:123], v[114:115], v[92:93], v[122:123] op_sel:[0,0,0] op_sel_hi:[0,1,1] neg_lo:[0,0,1]
    v_cvt_pk_bf16_f32 v132, v122, v123
    v_pk_mul_f32 v[124:125], v[116:117], v[92:93] op_sel:[1,1] op_sel_hi:[1,0]
    v_pk_fma_f32 v[124:125], v[116:117], v[92:93], v[124:125] op_sel:[0,0,0] op_sel_hi:[0,1,1] neg_lo:[0,0,1]
    v_cvt_pk_bf16_f32 v133, v124, v125
    v_pk_mul_f32 v[126:127], v[118:119], v[92:93] op_sel:[1,1] op_sel_hi:[1,0]
    v_pk_fma_f32 v[126:127], v[118:119], v[92:93], v[126:127] op_sel:[0,0,0] op_sel_hi:[0,1,1] neg_lo:[0,0,1]
    v_cvt_pk_bf16_f32 v134, v126, v127
    v_pk_mul_f32 v[112:113], v[120:121], v[92:93] op_sel:[1,1] op_sel_hi:[1,0]
    v_pk_fma_f32 v[112:113], v[120:121], v[92:93], v[112:113] op_sel:[0,0,0] op_sel_hi:[0,1,1] neg_lo:[0,0,1]
    v_cvt_pk_bf16_f32 v135, v112, v113
    ds_write_addtid_b32 v132 offset:13520
    ds_write_addtid_b32 v133 offset:14560
    ds_write_addtid_b32 v134 offset:15600
    ds_write_addtid_b32 v135 offset:16640
    v_pk_mul_f32 v[114:115], v[122:123], v[92:93] op_sel:[1,1] op_sel_hi:[1,0]
    v_pk_fma_f32 v[114:115], v[122:123], v[92:93], v[114:115] op_sel:[0,0,0] op_sel_hi:[0,1,1] neg_lo:[0,0,1]
    v_cvt_pk_bf16_f32 v128, v114, v115
    v_pk_mul_f32 v[116:117], v[124:125], v[92:93] op_sel:[1,1] op_sel_hi:[1,0]
    v_pk_fma_f32 v[116:117], v[124:125], v[92:93], v[116:117] op_sel:[0,0,0] op_sel_hi:[0,1,1] neg_lo:[0,0,1]
    v_cvt_pk_bf16_f32 v129, v116, v117
    v_pk_mul_f32 v[118:119], v[126:127], v[92:93] op_sel:[1,1] op_sel_hi:[1,0]
    v_pk_fma_f32 v[118:119], v[126:127], v[92:93], v[118:119] op_sel:[0,0,0] op_sel_hi:[0,1,1] neg_lo:[0,0,1]
    v_cvt_pk_bf16_f32 v130, v118, v119
    v_pk_mul_f32 v[120:121], v[112:113], v[92:93] op_sel:[1,1] op_sel_hi:[1,0]
    v_pk_fma_f32 v[120:121], v[112:113], v[92:93], v[120:121] op_sel:[0,0,0] op_sel_hi:[0,1,1] neg_lo:[0,0,1]
    v_cvt_pk_bf16_f32 v131, v120, v121
    ds_write_addtid_b32 v128 offset:17680
    ds_write_addtid_b32 v129 offset:18720
    ds_write_addtid_b32 v130 offset:19760
    ds_write_addtid_b32 v131 offset:20800
    v_pk_mul_f32 v[122:123], v[114:115], v[92:93] op_sel:[1,1] op_sel_hi:[1,0]
    v_pk_fma_f32 v[122:123], v[114:115], v[92:93], v[122:123] op_sel:[0,0,0] op_sel_hi:[0,1,1] neg_lo:[0,0,1]
    v_cvt_pk_bf16_f32 v132, v122, v123
    v_pk_mul_f32 v[124:125], v[116:117], v[92:93] op_sel:[1,1] op_sel_hi:[1,0]
    v_pk_fma_f32 v[124:125], v[116:117], v[92:93], v[124:125] op_sel:[0,0,0] op_sel_hi:[0,1,1] neg_lo:[0,0,1]
    v_cvt_pk_bf16_f32 v133, v124, v125
    v_pk_mul_f32 v[126:127], v[118:119], v[92:93] op_sel:[1,1] op_sel_hi:[1,0]
    v_pk_fma_f32 v[126:127], v[118:119], v[92:93], v[126:127] op_sel:[0,0,0] op_sel_hi:[0,1,1] neg_lo:[0,0,1]
    v_cvt_pk_bf16_f32 v134, v126, v127
    v_pk_mul_f32 v[112:113], v[120:121], v[92:93] op_sel:[1,1] op_sel_hi:[1,0]
    v_pk_fma_f32 v[112:113], v[120:121], v[92:93], v[112:113] op_sel:[0,0,0] op_sel_hi:[0,1,1] neg_lo:[0,0,1]
    v_cvt_pk_bf16_f32 v135, v112, v113
    ds_write_addtid_b32 v132 offset:21840
    ds_write_addtid_b32 v133 offset:22880
    ds_write_addtid_b32 v134 offset:23920
    ds_write_addtid_b32 v135 offset:24960
    v_pk_mul_f32 v[114:115], v[122:123], v[92:93] op_sel:[1,1] op_sel_hi:[1,0]
    v_pk_fma_f32 v[114:115], v[122:123], v[92:93], v[114:115] op_sel:[0,0,0] op_sel_hi:[0,1,1] neg_lo:[0,0,1]
    v_cvt_pk_bf16_f32 v128, v114, v115
    v_pk_mul_f32 v[116:117], v[124:125], v[92:93] op_sel:[1,1] op_sel_hi:[1,0]
    v_pk_fma_f32 v[116:117], v[124:125], v[92:93], v[116:117] op_sel:[0,0,0] op_sel_hi:[0,1,1] neg_lo:[0,0,1]
    v_cvt_pk_bf16_f32 v129, v116, v117
    v_pk_mul_f32 v[118:119], v[126:127], v[92:93] op_sel:[1,1] op_sel_hi:[1,0]
    v_pk_fma_f32 v[118:119], v[126:127], v[92:93], v[118:119] op_sel:[0,0,0] op_sel_hi:[0,1,1] neg_lo:[0,0,1]
    v_cvt_pk_bf16_f32 v130, v118, v119
    v_pk_mul_f32 v[120:121], v[112:113], v[92:93] op_sel:[1,1] op_sel_hi:[1,0]
    v_pk_fma_f32 v[120:121], v[112:113], v[92:93], v[120:121] op_sel:[0,0,0] op_sel_hi:[0,1,1] neg_lo:[0,0,1]
    v_cvt_pk_bf16_f32 v131, v120, v121
    ds_write_addtid_b32 v128 offset:26000
    ds_write_addtid_b32 v129 offset:27040
    ds_write_addtid_b32 v130 offset:28080
    ds_write_addtid_b32 v131 offset:29120
    v_pk_mul_f32 v[122:123], v[114:115], v[92:93] op_sel:[1,1] op_sel_hi:[1,0]
    v_pk_fma_f32 v[122:123], v[114:115], v[92:93], v[122:123] op_sel:[0,0,0] op_sel_hi:[0,1,1] neg_lo:[0,0,1]
    v_cvt_pk_bf16_f32 v132, v122, v123
    v_pk_mul_f32 v[124:125], v[116:117], v[92:93] op_sel:[1,1] op_sel_hi:[1,0]
    v_pk_fma_f32 v[124:125], v[116:117], v[92:93], v[124:125] op_sel:[0,0,0] op_sel_hi:[0,1,1] neg_lo:[0,0,1]
    v_cvt_pk_bf16_f32 v133, v124, v125
    v_pk_mul_f32 v[126:127], v[118:119], v[92:93] op_sel:[1,1] op_sel_hi:[1,0]
    v_pk_fma_f32 v[126:127], v[118:119], v[92:93], v[126:127] op_sel:[0,0,0] op_sel_hi:[0,1,1] neg_lo:[0,0,1]
    v_cvt_pk_bf16_f32 v134, v126, v127
    v_mul_f32 v74, v78, v74
    v_mul_f32 v75, v78, v75
    v_pk_mul_f32 v[96:97], v[76:77], v[74:75] op_sel:[1,1] op_sel_hi:[1,0]
    v_pk_fma_f32 v[96:97], v[76:77], v[74:75], v[96:97] op_sel:[0,0,0] op_sel_hi:[0,1,1] neg_lo:[0,0,1]
    v_pk_mul_f32 v[98:99], v[96:97], v[80:81] op_sel:[1,1] op_sel_hi:[1,0]
    v_pk_fma_f32 v[98:99], v[96:97], v[80:81], v[98:99] op_sel:[0,0,0] op_sel_hi:[0,1,1] neg_lo:[0,0,1]
    v_cvt_pk_bf16_f32 v135, v96, -v97
    ds_write_addtid_b32 v132 offset:30160
    ds_write_addtid_b32 v133 offset:31200
    ds_write_addtid_b32 v134 offset:32240
    ds_write_addtid_b32 v135 offset:33280
    v_pk_mul_f32 v[100:101], v[96:97], v[82:83] op_sel:[1,1] op_sel_hi:[1,0]
    v_pk_fma_f32 v[100:101], v[96:97], v[82:83], v[100:101] op_sel:[0,0,0] op_sel_hi:[0,1,1] neg_lo:[0,0,1]
    v_cvt_pk_bf16_f32 v128, v98, -v99
    v_pk_mul_f32 v[102:103], v[98:99], v[82:83] op_sel:[1,1] op_sel_hi:[1,0]
    v_pk_fma_f32 v[102:103], v[98:99], v[82:83], v[102:103] op_sel:[0,0,0] op_sel_hi:[0,1,1] neg_lo:[0,0,1]
    v_cvt_pk_bf16_f32 v129, v100, -v101
    v_pk_mul_f32 v[104:105], v[96:97], v[84:85] op_sel:[1,1] op_sel_hi:[1,0]
    v_pk_fma_f32 v[104:105], v[96:97], v[84:85], v[104:105] op_sel:[0,0,0] op_sel_hi:[0,1,1] neg_lo:[0,0,1]
    v_cvt_pk_bf16_f32 v130, v102, -v103
    v_pk_mul_f32 v[106:107], v[98:99], v[84:85] op_sel:[1,1] op_sel_hi:[1,0]
    v_pk_fma_f32 v[106:107], v[98:99], v[84:85], v[106:107] op_sel:[0,0,0] op_sel_hi:[0,1,1] neg_lo:[0,0,1]
    v_cvt_pk_bf16_f32 v131, v104, -v105
    ds_write_addtid_b32 v128 offset:34320
    ds_write_addtid_b32 v129 offset:35360
    ds_write_addtid_b32 v130 offset:36400
    ds_write_addtid_b32 v131 offset:37440
    v_pk_mul_f32 v[108:109], v[100:101], v[84:85] op_sel:[1,1] op_sel_hi:[1,0]
    v_pk_fma_f32 v[108:109], v[100:101], v[84:85], v[108:109] op_sel:[0,0,0] op_sel_hi:[0,1,1] neg_lo:[0,0,1]
    v_cvt_pk_bf16_f32 v132, v106, -v107
    v_pk_mul_f32 v[110:111], v[102:103], v[84:85] op_sel:[1,1] op_sel_hi:[1,0]
    v_pk_fma_f32 v[110:111], v[102:103], v[84:85], v[110:111] op_sel:[0,0,0] op_sel_hi:[0,1,1] neg_lo:[0,0,1]
    v_cvt_pk_bf16_f32 v133, v108, -v109
    v_pk_mul_f32 v[112:113], v[96:97], v[86:87] op_sel:[1,1] op_sel_hi:[1,0]
    v_pk_fma_f32 v[112:113], v[96:97], v[86:87], v[112:113] op_sel:[0,0,0] op_sel_hi:[0,1,1] neg_lo:[0,0,1]
    v_cvt_pk_bf16_f32 v134, v110, -v111
    v_pk_mul_f32 v[114:115], v[100:101], v[86:87] op_sel:[1,1] op_sel_hi:[1,0]
    v_pk_fma_f32 v[114:115], v[100:101], v[86:87], v[114:115] op_sel:[0,0,0] op_sel_hi:[0,1,1] neg_lo:[0,0,1]
    v_cvt_pk_bf16_f32 v135, v112, -v113
    ds_write_addtid_b32 v132 offset:38480
    ds_write_addtid_b32 v133 offset:39520
    ds_write_addtid_b32 v134 offset:40560
    ds_write_addtid_b32 v135 offset:41600
    v_pk_mul_f32 v[116:117], v[104:105], v[86:87] op_sel:[1,1] op_sel_hi:[1,0]
    v_pk_fma_f32 v[116:117], v[104:105], v[86:87], v[116:117] op_sel:[0,0,0] op_sel_hi:[0,1,1] neg_lo:[0,0,1]
    v_cvt_pk_bf16_f32 v128, v114, -v115
    v_pk_mul_f32 v[118:119], v[108:109], v[86:87] op_sel:[1,1] op_sel_hi:[1,0]
    v_pk_fma_f32 v[118:119], v[108:109], v[86:87], v[118:119] op_sel:[0,0,0] op_sel_hi:[0,1,1] neg_lo:[0,0,1]
    v_cvt_pk_bf16_f32 v129, v116, -v117
    v_pk_mul_f32 v[120:121], v[112:113], v[86:87] op_sel:[1,1] op_sel_hi:[1,0]
    v_pk_fma_f32 v[120:121], v[112:113], v[86:87], v[120:121] op_sel:[0,0,0] op_sel_hi:[0,1,1] neg_lo:[0,0,1]
    v_cvt_pk_bf16_f32 v130, v118, -v119
    v_pk_mul_f32 v[122:123], v[116:117], v[86:87] op_sel:[1,1] op_sel_hi:[1,0]
    v_pk_fma_f32 v[122:123], v[116:117], v[86:87], v[122:123] op_sel:[0,0,0] op_sel_hi:[0,1,1] neg_lo:[0,0,1]
    v_cvt_pk_bf16_f32 v131, v120, -v121
    ds_write_addtid_b32 v128 offset:42640
    ds_write_addtid_b32 v129 offset:43680
    ds_write_addtid_b32 v130 offset:44720
    ds_write_addtid_b32 v131 offset:45760
    v_pk_mul_f32 v[124:125], v[120:121], v[86:87] op_sel:[1,1] op_sel_hi:[1,0]
    v_pk_fma_f32 v[124:125], v[120:121], v[86:87], v[124:125] op_sel:[0,0,0] op_sel_hi:[0,1,1] neg_lo:[0,0,1]
    v_cvt_pk_bf16_f32 v132, v122, -v123
    v_pk_mul_f32 v[126:127], v[122:123], v[86:87] op_sel:[1,1] op_sel_hi:[1,0]
    v_pk_fma_f32 v[126:127], v[122:123], v[86:87], v[126:127] op_sel:[0,0,0] op_sel_hi:[0,1,1] neg_lo:[0,0,1]
    v_cvt_pk_bf16_f32 v133, v124, -v125
    v_pk_mul_f32 v[98:99], v[124:125], v[86:87] op_sel:[1,1] op_sel_hi:[1,0]
    v_pk_fma_f32 v[98:99], v[124:125], v[86:87], v[98:99] op_sel:[0,0,0] op_sel_hi:[0,1,1] neg_lo:[0,0,1]
    v_cvt_pk_bf16_f32 v134, v126, -v127
    v_pk_mul_f32 v[100:101], v[98:99], v[86:87] op_sel:[1,1] op_sel_hi:[1,0]
    v_pk_fma_f32 v[100:101], v[98:99], v[86:87], v[100:101] op_sel:[0,0,0] op_sel_hi:[0,1,1] neg_lo:[0,0,1]
    v_cvt_pk_bf16_f32 v135, v98, -v99
    ds_write_addtid_b32 v132 offset:46800
    ds_write_addtid_b32 v133 offset:47840
    ds_write_addtid_b32 v134 offset:48880
    ds_write_addtid_b32 v135 offset:49920
    v_pk_mul_f32 v[102:103], v[100:101], v[86:87] op_sel:[1,1] op_sel_hi:[1,0]
    v_pk_fma_f32 v[102:103], v[100:101], v[86:87], v[102:103] op_sel:[0,0,0] op_sel_hi:[0,1,1] neg_lo:[0,0,1]
    v_cvt_pk_bf16_f32 v128, v100, -v101
    v_pk_mul_f32 v[104:105], v[102:103], v[86:87] op_sel:[1,1] op_sel_hi:[1,0]
    v_pk_fma_f32 v[104:105], v[102:103], v[86:87], v[104:105] op_sel:[0,0,0] op_sel_hi:[0,1,1] neg_lo:[0,0,1]
    v_cvt_pk_bf16_f32 v129, v102, -v103
    v_pk_mul_f32 v[106:107], v[104:105], v[86:87] op_sel:[1,1] op_sel_hi:[1,0]
    v_pk_fma_f32 v[106:107], v[104:105], v[86:87], v[106:107] op_sel:[0,0,0] op_sel_hi:[0,1,1] neg_lo:[0,0,1]
    v_cvt_pk_bf16_f32 v130, v104, -v105
    v_cvt_pk_bf16_f32 v131, v106, -v107
    ds_write_addtid_b32 v128 offset:50960
    ds_write_addtid_b32 v129 offset:52000
    ds_write_addtid_b32 v130 offset:53040
    ds_write_addtid_b32 v131 offset:54080
    ds_read_b128 v[88:91], v24 offset:0
    ds_read_b128 v[92:95], v25 offset:0
    ds_read_b128 v[96:99], v24 offset:32
    ds_read_b128 v[100:103], v25 offset:32
    ds_read_b128 v[104:107], v24 offset:64
    ds_read_b128 v[108:111], v25 offset:64
    ds_read_b128 v[112:115], v24 offset:96
    ds_read_b128 v[116:119], v25 offset:96
    ds_read_b128 v[120:123], v24 offset:128
    ds_read_b128 v[124:127], v25 offset:128
    ds_read_b128 v[128:131], v24 offset:160
    ds_read_b128 v[132:135], v25 offset:160
    s_waitcnt lgkmcnt(10)
    v_mfma_f32_32x32x16_bf16 v[72:87], v[88:91], v[92:95], 0
    ds_read_b128 v[88:91], v24 offset:192
    ds_read_b128 v[92:95], v25 offset:192
    s_waitcnt lgkmcnt(10)
    v_mfma_f32_32x32x16_bf16 v[72:87], v[96:99], v[100:103], v[72:87]
    ds_read_b128 v[96:99], v24 offset:224
    ds_read_b128 v[100:103], v25 offset:224
    s_waitcnt lgkmcnt(10)
    v_mfma_f32_32x32x16_bf16 v[72:87], v[104:107], v[108:111], v[72:87]
    s_waitcnt lgkmcnt(8)
    v_mfma_f32_32x32x16_bf16 v[72:87], v[112:115], v[116:119], v[72:87]
    s_waitcnt lgkmcnt(6)
    v_mfma_f32_32x32x16_bf16 v[72:87], v[120:123], v[124:127], v[72:87]
    s_waitcnt lgkmcnt(4)
    v_mfma_f32_32x32x16_bf16 v[72:87], v[128:131], v[132:135], v[72:87]
    s_waitcnt lgkmcnt(2)
    v_mfma_f32_32x32x16_bf16 v[72:87], v[88:91], v[92:95], v[72:87]
    s_waitcnt lgkmcnt(0)
    v_mfma_f32_32x32x16_bf16 v[72:87], v[96:99], v[100:103], v[72:87]
    v_mov_b32 v247, 1
    s_cmp_eq_u32 s63, 1
    s_cbranch_scc1 L_c_half1
    s_nop 8
    ds_write_b128 v26, v[72:75] offset:0
    ds_write_b128 v26, v[76:79] offset:1024
    ds_write_b128 v26, v[80:83] offset:2048
    s_mov_b64 exec, 1
    ds_write_b32 v35, v247
    s_mov_b64 exec, -1
    s_mul_i32 s58, s39, 43
    s_add_u32 s58, s58, 43
    s_lshr_b32 s58, s58, 3
    s_sub_u32 s58, s58, s56
    s_lshl_b32 s58, s58, 2
    s_lshl_b32 s50, s56, 2
    s_add_u32 s50, s50, s40
    s_cmp_lt_u32 s40, s58
    s_cselect_b32 s51, 1, 0
    s_mul_i32 s60, s39, 24
    s_add_u32 s60, s60, s40
    s_lshl_b32 s60, s60, 12
    s_add_u32 s60, s60, 3145728
    s_lshl_b32 s59, s38, 12
    s_add_u32 s59, s59, 110720
    v_lshl_add_u32 v65, v1, 4, s60
    v_lshl_add_u32 v64, v1, 4, s59
    v_lshl_add_u32 v66, v1, 2, s59
    v_lshrrev_b32 v244, 1, v0
    v_mul_u32_u24 v244, 6144, v244
    v_and_b32 v243, 1, v1
    v_lshl_add_u32 v244, v243, 4, v244
    s_lshl_b32 s60, s50, 5
    s_add_u32 s60, s60, 65536
    v_add_u32 v67, s60, v244
    s_lshr_b32 s58, s41, 2
    s_and_b32 s59, s40, 1
    s_mul_i32 s58, s58, 6144
    s_add_u32 s58, s58, 67584
    s_lshl_b32 s61, s59, 4
    s_add_u32 s58, s58, s61
    v_lshl_add_u32 v68, v1, 5, s58
    s_mul_i32 s58, s57, 18560
    s_add_u32 s58, s58, 55168
    s_mul_i32 s59, s63, 1152
    s_add_u32 s58, s58, s59
    v_and_b32 v245, 15, v1
    v_lshrrev_b32 v246, 4, v1
    v_lshlrev_b32 v243, 3, v246
    v_sub_u32 v243, v245, v243
    v_add_u32 v244, 32, v243
    v_lshrrev_b32 v247, 4, v244
    v_lshl_add_u32 v28, v244, 3, s58
    v_lshl_add_u32 v28, v247, 4, v28
    v_add_u32 v244, 28, v243
    v_lshrrev_b32 v247, 4, v244
    v_lshl_add_u32 v29, v244, 3, s58
    v_lshl_add_u32 v29, v247, 4, v29
    s_mul_i32 s58, s57, 4576
    s_add_u32 s58, s58, 92288
    s_mul_i32 s60, s38, 10240
    s_lshl_b32 s59, s63, 8
    s_sub_u32 s58, s58, s59
    v_lshl_add_u32 v243, v246, 4, s58
    v_lshl_add_u32 v30, v245, 5, v243
    v_mul_u32_u24 v243, 320, v246
    v_lshl_add_u32 v243, v245, 4, v243
    v_add_u32 v27, s60, v243
    s_branch L_c_tab
L_c_half1:
    s_mov_b32 s54, 65536
L_pspin:
    ds_read_b32 v246, v35
    ds_read_b128 v[48:51], v26 offset:0
    ds_read_b128 v[52:55], v26 offset:1024
    ds_read_b128 v[56:59], v26 offset:2048
    s_waitcnt lgkmcnt(3)
    v_readfirstlane_b32 s58, v246
    s_nop 0
    s_cmp_lg_u32 s58, 0
    s_cbranch_scc1 L_pok
    s_waitcnt lgkmcnt(0)
    s_sub_u32 s54, s54, 1
    s_cmp_lg_u32 s54, 0
    s_cbranch_scc1 L_pspin
L_pok:
    s_waitcnt lgkmcnt(0)
    v_add_f32 v72, v72, v48
    v_add_f32 v73, v73, v49
    v_add_f32 v74, v74, v50
    v_add_f32 v75, v75, v51
    v_add_f32 v76, v76, v52
    v_add_f32 v77, v77, v53
    v_add_f32 v78, v78, v54
    v_add_f32 v79, v79, v55
    v_add_f32 v80, v80, v56
    v_add_f32 v81, v81, v57
    v_add_f32 v82, v82, v58
    v_add_f32 v83, v83, v59
    v_cvt_pk_bf16_f32 v240, v72, v73
    v_cvt_pk_bf16_f32 v241, v74, v75
    v_cvt_pk_bf16_f32 v242, v76, v77
    v_cvt_pk_bf16_f32 v243, v78, v79
    v_cvt_pk_bf16_f32 v244, v80, v81
    v_cvt_pk_bf16_f32 v245, v82, v83
    ds_write_b64 v31, v[240:241]
    ds_write_b32 v32, v242
    ds_write_b32 v33, v243
    ds_write_b16 v34, v244
    ds_write_b16_d16_hi v34, v244 offset:64
    ds_write_b16 v34, v245 offset:128
    ds_write_b16_d16_hi v34, v245 offset:192
    s_mov_b64 exec, 1
    ds_write_b32 v35, v247 offset:8
    s_mov_b64 exec, -1
L_c_tab:
    s_mov_b32 s54, 65536
    v_mov_b32 v249, 135296
L_tspin:
    ds_read_b64 v[240:241], v249 offset:32
    ds_read2_b32 v[72:73], v2 offset0:0 offset1:1
    ds_read2_b32 v[74:75], v3 offset0:0 offset1:1
    ds_read2_b32 v[76:77], v4 offset0:0 offset1:1
    ds_read2_b32 v[78:79], v5 offset0:0 offset1:1
    ds_read2_b32 v[80:81], v6 offset0:0 offset1:1
    ds_read2_b32 v[82:83], v7 offset0:0 offset1:1
    ds_read2_b32 v[84:85], v8 offset0:0 offset1:1
    ds_read2_b32 v[86:87], v9 offset0:0 offset1:1
    s_waitcnt lgkmcnt(8)
    v_and_b32 v240, v240, v241
    s_nop 0
    v_readfirstlane_b32 s58, v240
    s_nop 0
    s_cmp_lg_u32 s58, 0
    s_cbranch_scc1 L_tok
    s_waitcnt lgkmcnt(0)
    s_sub_u32 s54, s54, 1
    s_cmp_lg_u32 s54, 0
    s_cbranch_scc1 L_tspin
L_tok:
    s_waitcnt lgkmcnt(6)
    v_perm_b32 v88, v74, v73, v12
    v_perm_b32 v89, v73, v72, v10
    v_perm_b32 v90, v75, v74, v13
    v_perm_b32 v91, v73, v72, v11
    v_perm_b32 v92, v75, v74, v14
    v_mov_b32 v93, v88
    v_perm_b32 v94, v75, v74, v15
    v_mov_b32 v95, v90
    ds_write_b128 v22, v[88:91] offset:0
    ds_write_b128 v22, v[92:95] offset:16
    s_waitcnt lgkmcnt(6)
    v_perm_b32 v96, v78, v77, v12
    v_perm_b32 v97, v77, v76, v10
    v_perm_b32 v98, v79, v78, v13
    v_perm_b32 v99, v77, v76, v11
    v_perm_b32 v100, v79, v78, v14
    v_mov_b32 v101, v96
    v_perm_b32 v102, v79, v78, v15
    v_mov_b32 v103, v98
    ds_write_b128 v22, v[96:99] offset:18560
    ds_write_b128 v22, v[100:103] offset:18576
    s_waitcnt lgkmcnt(6)
    v_perm_b32 v104, v82, v81, v18
    v_perm_b32 v105, v81, v80, v16
    v_perm_b32 v106, v83, v82, v19
    v_perm_b32 v107, v81, v80, v17
    v_perm_b32 v108, v83, v82, v20
    v_mov_b32 v109, v104
    v_perm_b32 v110, v83, v82, v21
    v_mov_b32 v111, v106
    ds_write_b128 v23, v[104:107] offset:0
    ds_write_b128 v23, v[108:111] offset:16
    s_waitcnt lgkmcnt(6)
    v_perm_b32 v112, v86, v85, v18
    v_perm_b32 v113, v85, v84, v16
    v_perm_b32 v114, v87, v86, v19
    v_perm_b32 v115, v85, v84, v17
    v_perm_b32 v116, v87, v86, v20
    v_mov_b32 v117, v112
    v_perm_b32 v118, v87, v86, v21
    v_mov_b32 v119, v114
    ds_write_b128 v23, v[112:115] offset:18560
    ds_write_b128 v23, v[116:119] offset:18576
    s_cmp_eq_u32 s63, 0
    s_cbranch_scc1 L_c_b4
    s_mul_i32 s58, s39, 43
    s_add_u32 s58, s58, 43
    s_lshr_b32 s58, s58, 3
    s_sub_u32 s58, s58, s56
    s_lshl_b32 s58, s58, 2
    s_lshl_b32 s50, s56, 2
    s_add_u32 s50, s50, s40
    s_cmp_lt_u32 s40, s58
    s_cselect_b32 s51, 1, 0
    s_mul_i32 s60, s39, 24
    s_add_u32 s60, s60, s40
    s_lshl_b32 s60, s60, 12
    s_add_u32 s60, s60, 3145728
    s_lshl_b32 s59, s38, 12
    s_add_u32 s59, s59, 110720
    v_lshl_add_u32 v65, v1, 4, s60
    v_lshl_add_u32 v64, v1, 4, s59
    v_lshl_add_u32 v66, v1, 2, s59
    v_lshrrev_b32 v244, 1, v0
    v_mul_u32_u24 v244, 6144, v244
    v_and_b32 v243, 1, v1
    v_lshl_add_u32 v244, v243, 4, v244
    s_lshl_b32 s60, s50, 5
    s_add_u32 s60, s60, 65536
    v_add_u32 v67, s60, v244
    s_lshr_b32 s58, s41, 2
    s_and_b32 s59, s40, 1
    s_mul_i32 s58, s58, 6144
    s_add_u32 s58, s58, 67584
    s_lshl_b32 s61, s59, 4
    s_add_u32 s58, s58, s61
    v_lshl_add_u32 v68, v1, 5, s58
    s_mul_i32 s58, s57, 18560
    s_add_u32 s58, s58, 55168
    s_mul_i32 s59, s63, 1152
    s_add_u32 s58, s58, s59
    v_and_b32 v245, 15, v1
    v_lshrrev_b32 v246, 4, v1
    v_lshlrev_b32 v243, 3, v246
    v_sub_u32 v243, v245, v243
    v_add_u32 v244, 32, v243
    v_lshrrev_b32 v247, 4, v244
    v_lshl_add_u32 v28, v244, 3, s58
    v_lshl_add_u32 v28, v247, 4, v28
    v_add_u32 v244, 28, v243
    v_lshrrev_b32 v247, 4, v244
    v_lshl_add_u32 v29, v244, 3, s58
    v_lshl_add_u32 v29, v247, 4, v29
    s_mul_i32 s58, s57, 4576
    s_add_u32 s58, s58, 92288
    s_mul_i32 s60, s38, 10240
    s_lshl_b32 s59, s63, 8
    s_sub_u32 s58, s58, s59
    v_lshl_add_u32 v243, v246, 4, s58
    v_lshl_add_u32 v30, v245, 5, v243
    v_mul_u32_u24 v243, 320, v246
    v_lshl_add_u32 v243, v245, 4, v243
    v_add_u32 v27, s60, v243
L_c_b4:
    s_waitcnt vmcnt(0)
    ds_write_b128 v64, v[144:147] offset:0
    ds_write_b128 v64, v[148:151] offset:1024
    ds_write_b128 v64, v[152:155] offset:2048
    ds_write_b128 v64, v[156:159] offset:3072
    s_lshl_b32 s58, s41, 1
    s_load_dword s48, s[20:21], s58
    s_waitcnt lgkmcnt(0)
    s_barrier
    s_setprio 1
    ds_read_b128 v[104:107], v30 offset:448
    ds_read_b64 v[108:109], v28 offset:0
    ds_read_b64 v[110:111], v29 offset:0
    ds_read_b128 v[112:115], v30 offset:960
    ds_read_b128 v[116:119], v30 offset:1472
    ds_read_b128 v[120:123], v30 offset:1984
    ds_read_b128 v[124:127], v30 offset:2496
    ds_read_b128 v[128:131], v30 offset:3008
    ds_read_b128 v[132:135], v30 offset:3520
    ds_read_b128 v[136:139], v30 offset:4032
    ds_read_b64 v[140:141], v28 offset:2304
    ds_read_b64 v[142:143], v29 offset:2304
    s_waitcnt lgkmcnt(6)
    v_mfma_f32_16x16x32_bf16 v[72:75], v[108:111], v[104:107], 0
    v_mfma_f32_16x16x32_bf16 v[76:79], v[108:111], v[112:115], 0
    ds_read_b64 v[144:145], v28 offset:4608
    v_mfma_f32_16x16x32_bf16 v[80:83], v[108:111], v[116:119], 0
    ds_read_b64 v[146:147], v29 offset:4608
    v_mfma_f32_16x16x32_bf16 v[84:87], v[108:111], v[120:123], 0
    s_waitcnt lgkmcnt(4)
    v_mfma_f32_16x16x32_bf16 v[88:91], v[108:111], v[124:127], 0
    v_mfma_f32_16x16x32_bf16 v[92:95], v[108:111], v[128:131], 0
    v_mfma_f32_16x16x32_bf16 v[96:99], v[108:111], v[132:135], 0
    v_mfma_f32_16x16x32_bf16 v[100:103], v[108:111], v[136:139], 0
    ds_read_b64 v[148:149], v28 offset:6912
    s_waitcnt lgkmcnt(3)
    v_mfma_f32_16x16x32_bf16 v[76:79], v[140:143], v[104:107], v[76:79]
    ds_read_b64 v[150:151], v29 offset:6912
    v_mfma_f32_16x16x32_bf16 v[80:83], v[140:143], v[112:115], v[80:83]
    v_mfma_f32_16x16x32_bf16 v[84:87], v[140:143], v[116:119], v[84:87]
    v_mfma_f32_16x16x32_bf16 v[88:91], v[140:143], v[120:123], v[88:91]
    v_mfma_f32_16x16x32_bf16 v[92:95], v[140:143], v[124:127], v[92:95]
    ds_read_b64 v[152:153], v28 offset:9216
    v_mfma_f32_16x16x32_bf16 v[96:99], v[140:143], v[128:131], v[96:99]
    ds_read_b64 v[154:155], v29 offset:9216
    v_mfma_f32_16x16x32_bf16 v[100:103], v[140:143], v[132:135], v[100:103]
    s_waitcnt lgkmcnt(4)
    v_mfma_f32_16x16x32_bf16 v[80:83], v[144:147], v[104:107], v[80:83]
    v_mfma_f32_16x16x32_bf16 v[84:87], v[144:147], v[112:115], v[84:87]
    ds_read_b64 v[156:157], v28 offset:11520
    v_mfma_f32_16x16x32_bf16 v[88:91], v[144:147], v[116:119], v[88:91]
    ds_read_b64 v[158:159], v29 offset:11520
    v_mfma_f32_16x16x32_bf16 v[92:95], v[144:147], v[120:123], v[92:95]
    v_mfma_f32_16x16x32_bf16 v[96:99], v[144:147], v[124:127], v[96:99]
    ds_read_b64 v[160:161], v28 offset:13824
    v_mfma_f32_16x16x32_bf16 v[100:103], v[144:147], v[128:131], v[100:103]
    ds_read_b64 v[162:163], v29 offset:13824
    s_waitcnt lgkmcnt(6)
    v_mfma_f32_16x16x32_bf16 v[84:87], v[148:151], v[104:107], v[84:87]
    ds_read_b64 v[164:165], v28 offset:16128
    v_mfma_f32_16x16x32_bf16 v[88:91], v[148:151], v[112:115], v[88:91]
    ds_read_b64 v[166:167], v29 offset:16128
    v_mfma_f32_16x16x32_bf16 v[92:95], v[148:151], v[116:119], v[92:95]
    ds_read_b128 v[168:171], v30 offset:384
    v_mfma_f32_16x16x32_bf16 v[96:99], v[148:151], v[120:123], v[96:99]
    ds_read_b64 v[172:173], v28 offset:288
    v_mfma_f32_16x16x32_bf16 v[100:103], v[148:151], v[124:127], v[100:103]
    ds_read_b64 v[174:175], v29 offset:288
    s_waitcnt lgkmcnt(9)
    v_mfma_f32_16x16x32_bf16 v[88:91], v[152:155], v[104:107], v[88:91]
    ds_read_b128 v[176:179], v30 offset:896
    v_mfma_f32_16x16x32_bf16 v[92:95], v[152:155], v[112:115], v[92:95]
    ds_read_b128 v[180:183], v30 offset:1408
    v_mfma_f32_16x16x32_bf16 v[96:99], v[152:155], v[116:119], v[96:99]
    ds_read_b128 v[184:187], v30 offset:1920
    v_mfma_f32_16x16x32_bf16 v[100:103], v[152:155], v[120:123], v[100:103]
    ds_read_b128 v[188:191], v30 offset:2432
    s_waitcnt lgkmcnt(9)
    v_mfma_f32_16x16x32_bf16 v[92:95], v[156:159], v[104:107], v[92:95]
    ds_read_b128 v[192:195], v30 offset:2944
    v_mfma_f32_16x16x32_bf16 v[96:99], v[156:159], v[112:115], v[96:99]
    ds_read_b128 v[196:199], v30 offset:3456
    v_mfma_f32_16x16x32_bf16 v[100:103], v[156:159], v[116:119], v[100:103]
    ds_read_b128 v[200:203], v30 offset:3968
    v_mfma_f32_16x16x32_bf16 v[96:99], v[160:163], v[104:107], v[96:99]
    ds_read_b64 v[204:205], v28 offset:2592
    v_mfma_f32_16x16x32_bf16 v[100:103], v[160:163], v[112:115], v[100:103]
    ds_read_b64 v[206:207], v29 offset:2592
    s_waitcnt lgkmcnt(7)
    v_mfma_f32_16x16x32_bf16 v[100:103], v[164:167], v[104:107], v[100:103]
    v_mfma_f32_16x16x32_bf16 v[72:75], v[172:175], v[168:171], v[72:75]
    v_mfma_f32_16x16x32_bf16 v[76:79], v[172:175], v[176:179], v[76:79]
    ds_read_b64 v[208:209], v28 offset:4896
    v_mfma_f32_16x16x32_bf16 v[80:83], v[172:175], v[180:183], v[80:83]
    ds_read_b64 v[210:211], v29 offset:4896
    s_waitcnt lgkmcnt(5)
    v_mfma_f32_16x16x32_bf16 v[84:87], v[172:175], v[184:187], v[84:87]
    v_mfma_f32_16x16x32_bf16 v[88:91], v[172:175], v[188:191], v[88:91]
    v_mfma_f32_16x16x32_bf16 v[92:95], v[172:175], v[192:195], v[92:95]
    v_mfma_f32_16x16x32_bf16 v[96:99], v[172:175], v[196:199], v[96:99]
    s_waitcnt lgkmcnt(4)
    v_mfma_f32_16x16x32_bf16 v[100:103], v[172:175], v[200:203], v[100:103]
    ds_read_b64 v[212:213], v28 offset:7200
    s_waitcnt lgkmcnt(3)
    v_mfma_f32_16x16x32_bf16 v[76:79], v[204:207], v[168:171], v[76:79]
    ds_read_b64 v[214:215], v29 offset:7200
    v_mfma_f32_16x16x32_bf16 v[80:83], v[204:207], v[176:179], v[80:83]
    v_mfma_f32_16x16x32_bf16 v[84:87], v[204:207], v[180:183], v[84:87]
    v_mfma_f32_16x16x32_bf16 v[88:91], v[204:207], v[184:187], v[88:91]
    v_mfma_f32_16x16x32_bf16 v[92:95], v[204:207], v[188:191], v[92:95]
    ds_read_b64 v[216:217], v28 offset:9504
    v_mfma_f32_16x16x32_bf16 v[96:99], v[204:207], v[192:195], v[96:99]
    ds_read_b64 v[218:219], v29 offset:9504
    v_mfma_f32_16x16x32_bf16 v[100:103], v[204:207], v[196:199], v[100:103]
    s_waitcnt lgkmcnt(4)
    v_mfma_f32_16x16x32_bf16 v[80:83], v[208:211], v[168:171], v[80:83]
    v_mfma_f32_16x16x32_bf16 v[84:87], v[208:211], v[176:179], v[84:87]
    ds_read_b64 v[220:221], v28 offset:11808
    v_mfma_f32_16x16x32_bf16 v[88:91], v[208:211], v[180:183], v[88:91]
    ds_read_b64 v[222:223], v29 offset:11808
    v_mfma_f32_16x16x32_bf16 v[92:95], v[208:211], v[184:187], v[92:95]
    v_mfma_f32_16x16x32_bf16 v[96:99], v[208:211], v[188:191], v[96:99]
    ds_read_b64 v[108:109], v28 offset:14112
    v_mfma_f32_16x16x32_bf16 v[100:103], v[208:211], v[192:195], v[100:103]
    ds_read_b64 v[110:111], v29 offset:14112
    s_waitcnt lgkmcnt(6)
    v_mfma_f32_16x16x32_bf16 v[84:87], v[212:215], v[168:171], v[84:87]
    ds_read_b64 v[136:137], v28 offset:16416
    v_mfma_f32_16x16x32_bf16 v[88:91], v[212:215], v[176:179], v[88:91]
    ds_read_b64 v[138:139], v29 offset:16416
    v_mfma_f32_16x16x32_bf16 v[92:95], v[212:215], v[180:183], v[92:95]
    ds_read_b128 v[140:143], v30 offset:320
    v_mfma_f32_16x16x32_bf16 v[96:99], v[212:215], v[184:187], v[96:99]
    ds_read_b64 v[132:133], v28 offset:576
    v_mfma_f32_16x16x32_bf16 v[100:103], v[212:215], v[188:191], v[100:103]
    ds_read_b64 v[134:135], v29 offset:576
    s_waitcnt lgkmcnt(9)
    v_mfma_f32_16x16x32_bf16 v[88:91], v[216:219], v[168:171], v[88:91]
    ds_read_b128 v[144:147], v30 offset:832
    v_mfma_f32_16x16x32_bf16 v[92:95], v[216:219], v[176:179], v[92:95]
    ds_read_b128 v[128:131], v30 offset:1344
    v_mfma_f32_16x16x32_bf16 v[96:99], v[216:219], v[180:183], v[96:99]
    ds_read_b128 v[148:151], v30 offset:1856
    v_mfma_f32_16x16x32_bf16 v[100:103], v[216:219], v[184:187], v[100:103]
    ds_read_b128 v[124:127], v30 offset:2368
    s_waitcnt lgkmcnt(9)
    v_mfma_f32_16x16x32_bf16 v[92:95], v[220:223], v[168:171], v[92:95]
    ds_read_b128 v[152:155], v30 offset:2880
    v_mfma_f32_16x16x32_bf16 v[96:99], v[220:223], v[176:179], v[96:99]
    ds_read_b128 v[120:123], v30 offset:3392
    v_mfma_f32_16x16x32_bf16 v[100:103], v[220:223], v[180:183], v[100:103]
    ds_read_b128 v[156:159], v30 offset:3904
    v_mfma_f32_16x16x32_bf16 v[96:99], v[108:111], v[168:171], v[96:99]
    ds_read_b64 v[116:117], v28 offset:2880
    v_mfma_f32_16x16x32_bf16 v[100:103], v[108:111], v[176:179], v[100:103]
    ds_read_b64 v[118:119], v29 offset:2880
    s_waitcnt lgkmcnt(7)
    v_mfma_f32_16x16x32_bf16 v[100:103], v[136:139], v[168:171], v[100:103]
    v_mfma_f32_16x16x32_bf16 v[72:75], v[132:135], v[140:143], v[72:75]
    v_mfma_f32_16x16x32_bf16 v[76:79], v[132:135], v[144:147], v[76:79]
    ds_read_b64 v[160:161], v28 offset:5184
    v_mfma_f32_16x16x32_bf16 v[80:83], v[132:135], v[128:131], v[80:83]
    ds_read_b64 v[162:163], v29 offset:5184
    s_waitcnt lgkmcnt(5)
    v_mfma_f32_16x16x32_bf16 v[84:87], v[132:135], v[148:151], v[84:87]
    v_mfma_f32_16x16x32_bf16 v[88:91], v[132:135], v[124:127], v[88:91]
    v_mfma_f32_16x16x32_bf16 v[92:95], v[132:135], v[152:155], v[92:95]
    v_mfma_f32_16x16x32_bf16 v[96:99], v[132:135], v[120:123], v[96:99]
    s_waitcnt lgkmcnt(4)
    v_mfma_f32_16x16x32_bf16 v[100:103], v[132:135], v[156:159], v[100:103]
    ds_read_b64 v[112:113], v28 offset:7488
    s_waitcnt lgkmcnt(3)
    v_mfma_f32_16x16x32_bf16 v[76:79], v[116:119], v[140:143], v[76:79]
    ds_read_b64 v[114:115], v29 offset:7488
    v_mfma_f32_16x16x32_bf16 v[80:83], v[116:119], v[144:147], v[80:83]
    v_mfma_f32_16x16x32_bf16 v[84:87], v[116:119], v[128:131], v[84:87]
    v_mfma_f32_16x16x32_bf16 v[88:91], v[116:119], v[148:151], v[88:91]
    v_mfma_f32_16x16x32_bf16 v[92:95], v[116:119], v[124:127], v[92:95]
    ds_read_b64 v[164:165], v28 offset:9792
    v_mfma_f32_16x16x32_bf16 v[96:99], v[116:119], v[152:155], v[96:99]
    ds_read_b64 v[166:167], v29 offset:9792
    v_mfma_f32_16x16x32_bf16 v[100:103], v[116:119], v[120:123], v[100:103]
    s_waitcnt lgkmcnt(4)
    v_mfma_f32_16x16x32_bf16 v[80:83], v[160:163], v[140:143], v[80:83]
    v_mfma_f32_16x16x32_bf16 v[84:87], v[160:163], v[144:147], v[84:87]
    ds_read_b64 v[104:105], v28 offset:12096
    v_mfma_f32_16x16x32_bf16 v[88:91], v[160:163], v[128:131], v[88:91]
    ds_read_b64 v[106:107], v29 offset:12096
    v_mfma_f32_16x16x32_bf16 v[92:95], v[160:163], v[148:151], v[92:95]
    v_mfma_f32_16x16x32_bf16 v[96:99], v[160:163], v[124:127], v[96:99]
    ds_read_b64 v[172:173], v28 offset:14400
    v_mfma_f32_16x16x32_bf16 v[100:103], v[160:163], v[152:155], v[100:103]
    ds_read_b64 v[174:175], v29 offset:14400
    s_waitcnt lgkmcnt(6)
    v_mfma_f32_16x16x32_bf16 v[84:87], v[112:115], v[140:143], v[84:87]
    ds_read_b64 v[200:201], v28 offset:16704
    v_mfma_f32_16x16x32_bf16 v[88:91], v[112:115], v[144:147], v[88:91]
    ds_read_b64 v[202:203], v29 offset:16704
    v_mfma_f32_16x16x32_bf16 v[92:95], v[112:115], v[128:131], v[92:95]
    ds_read_b128 v[204:207], v30 offset:256
    v_mfma_f32_16x16x32_bf16 v[96:99], v[112:115], v[148:151], v[96:99]
    ds_read_b64 v[196:197], v28 offset:864
    v_mfma_f32_16x16x32_bf16 v[100:103], v[112:115], v[124:127], v[100:103]
    ds_read_b64 v[198:199], v29 offset:864
    s_waitcnt lgkmcnt(9)
    v_mfma_f32_16x16x32_bf16 v[88:91], v[164:167], v[140:143], v[88:91]
    ds_read_b128 v[208:211], v30 offset:768
    v_mfma_f32_16x16x32_bf16 v[92:95], v[164:167], v[144:147], v[92:95]
    ds_read_b64 v[192:193], v28 offset:3168
    v_mfma_f32_16x16x32_bf16 v[96:99], v[164:167], v[128:131], v[96:99]
    ds_read_b64 v[194:195], v29 offset:3168
    v_mfma_f32_16x16x32_bf16 v[100:103], v[164:167], v[148:151], v[100:103]
    ds_read_b128 v[212:215], v30 offset:1280
    s_waitcnt lgkmcnt(9)
    v_mfma_f32_16x16x32_bf16 v[92:95], v[104:107], v[140:143], v[92:95]
    ds_read_b64 v[188:189], v28 offset:5472
    v_mfma_f32_16x16x32_bf16 v[96:99], v[104:107], v[144:147], v[96:99]
    ds_read_b64 v[190:191], v29 offset:5472
    v_mfma_f32_16x16x32_bf16 v[100:103], v[104:107], v[128:131], v[100:103]
    ds_read_b128 v[216:219], v30 offset:1792
    v_mfma_f32_16x16x32_bf16 v[96:99], v[172:175], v[140:143], v[96:99]
    ds_read_b64 v[184:185], v28 offset:7776
    v_mfma_f32_16x16x32_bf16 v[100:103], v[172:175], v[144:147], v[100:103]
    ds_read_b64 v[186:187], v29 offset:7776
    s_waitcnt lgkmcnt(6)
    v_mfma_f32_16x16x32_bf16 v[100:103], v[200:203], v[140:143], v[100:103]
    ds_read_b128 v[220:223], v30 offset:2304
    v_mfma_f32_16x16x32_bf16 v[72:75], v[196:199], v[204:207], v[72:75]
    ds_read_b64 v[180:181], v28 offset:10080
    v_mfma_f32_16x16x32_bf16 v[76:79], v[196:199], v[208:211], v[76:79]
    ds_read_b64 v[182:183], v29 offset:10080
    v_mfma_f32_16x16x32_bf16 v[76:79], v[192:195], v[204:207], v[76:79]
    v_mfma_f32_16x16x32_bf16 v[80:83], v[192:195], v[208:211], v[80:83]
    s_waitcnt lgkmcnt(6)
    v_mfma_f32_16x16x32_bf16 v[80:83], v[196:199], v[212:215], v[80:83]
    v_mfma_f32_16x16x32_bf16 v[80:83], v[188:191], v[204:207], v[80:83]
    ds_write_b128 v27, v[72:75] offset:0
    v_mfma_f32_16x16x32_bf16 v[84:87], v[192:195], v[212:215], v[84:87]
    ds_read_b128 v[108:111], v30 offset:2816
    v_mfma_f32_16x16x32_bf16 v[84:87], v[188:191], v[208:211], v[84:87]
    ds_write_b128 v27, v[76:79] offset:1280
    s_waitcnt lgkmcnt(6)
    v_mfma_f32_16x16x32_bf16 v[84:87], v[196:199], v[216:219], v[84:87]
    ds_read_b64 v[176:177], v28 offset:12384
    v_mfma_f32_16x16x32_bf16 v[84:87], v[184:187], v[204:207], v[84:87]
    ds_read_b64 v[178:179], v29 offset:12384
    v_mfma_f32_16x16x32_bf16 v[88:91], v[188:191], v[212:215], v[88:91]
    ds_write_b128 v27, v[80:83] offset:2560
    v_mfma_f32_16x16x32_bf16 v[88:91], v[192:195], v[216:219], v[88:91]
    v_mfma_f32_16x16x32_bf16 v[88:91], v[184:187], v[208:211], v[88:91]
    ds_read_b128 v[136:139], v30 offset:3328
    s_waitcnt lgkmcnt(7)
    v_mfma_f32_16x16x32_bf16 v[88:91], v[196:199], v[220:223], v[88:91]
    ds_read_b64 v[168:169], v28 offset:14688
    v_mfma_f32_16x16x32_bf16 v[88:91], v[180:183], v[204:207], v[88:91]
    ds_write_b128 v27, v[84:87] offset:3840
    v_mfma_f32_16x16x32_bf16 v[92:95], v[188:191], v[216:219], v[92:95]
    ds_read_b64 v[170:171], v29 offset:14688
    v_mfma_f32_16x16x32_bf16 v[92:95], v[184:187], v[212:215], v[92:95]
    v_mfma_f32_16x16x32_bf16 v[92:95], v[192:195], v[220:223], v[92:95]
    v_mfma_f32_16x16x32_bf16 v[92:95], v[180:183], v[208:211], v[92:95]
    s_waitcnt lgkmcnt(8)
    v_mfma_f32_16x16x32_bf16 v[92:95], v[196:199], v[108:111], v[92:95]
    ds_write_b128 v27, v[88:91] offset:5120
    s_waitcnt lgkmcnt(6)
    v_mfma_f32_16x16x32_bf16 v[92:95], v[176:179], v[204:207], v[92:95]
    ds_read_b128 v[132:135], v30 offset:3840
    v_mfma_f32_16x16x32_bf16 v[96:99], v[184:187], v[216:219], v[96:99]
    ds_read_b64 v[156:157], v28 offset:16992
    v_mfma_f32_16x16x32_bf16 v[96:99], v[188:191], v[220:223], v[96:99]
    ds_read_b64 v[158:159], v29 offset:16992
    v_mfma_f32_16x16x32_bf16 v[96:99], v[180:183], v[212:215], v[96:99]
    v_mfma_f32_16x16x32_bf16 v[96:99], v[192:195], v[108:111], v[96:99]
    v_mfma_f32_16x16x32_bf16 v[96:99], v[176:179], v[208:211], v[96:99]
    ds_write_b128 v27, v[92:95] offset:6400
    s_waitcnt lgkmcnt(5)
    v_mfma_f32_16x16x32_bf16 v[96:99], v[196:199], v[136:139], v[96:99]
    v_mfma_f32_16x16x32_bf16 v[96:99], v[168:171], v[204:207], v[96:99]
    v_mfma_f32_16x16x32_bf16 v[100:103], v[184:187], v[220:223], v[100:103]
    v_mfma_f32_16x16x32_bf16 v[100:103], v[180:183], v[216:219], v[100:103]
    v_mfma_f32_16x16x32_bf16 v[100:103], v[188:191], v[108:111], v[100:103]
    v_mfma_f32_16x16x32_bf16 v[100:103], v[176:179], v[212:215], v[100:103]
    v_mfma_f32_16x16x32_bf16 v[100:103], v[192:195], v[136:139], v[100:103]
    s_nop 2
    ds_write_b128 v27, v[96:99] offset:7680
    v_mfma_f32_16x16x32_bf16 v[100:103], v[168:171], v[208:211], v[100:103]
    s_waitcnt lgkmcnt(2)
    v_mfma_f32_16x16x32_bf16 v[100:103], v[196:199], v[132:135], v[100:103]
    v_mfma_f32_16x16x32_bf16 v[100:103], v[156:159], v[204:207], v[100:103]
    s_nop 7
    ds_write_b128 v27, v[100:103] offset:8960
    s_setprio 0
    s_waitcnt lgkmcnt(0)
    s_barrier
L_c_nos2:
    s_cmp_lg_u32 s38, 0
    s_cbranch_scc1 L_exit
    v_mov_b32 v249, 135296
    ds_read_b128 v[240:243], v249
    ds_read_b64 v[244:245], v249 offset:16
    s_waitcnt lgkmcnt(0)
    v_max3_u32 v240, v240, v241, v242
    v_readfirstlane_b32 s46, v244
    v_max_u32 v240, v240, v243
    v_readfirstlane_b32 s44, v245
    v_readfirstlane_b32 s53, v240
    s_nop 0
    s_andn2_b32 s52, 2047, s53
    s_and_b32 s43, s44, -16
    s_cmp_lg_u32 s2, 0
    s_cbranch_scc1 L_noep
    s_mov_b32 s58, s43
    v_mov_b32 v250, 0
    v_mov_b32 v251, s58
    s_mov_b64 exec, 1
    global_store_dword v250, v251, s[36:37] sc1
    s_mov_b64 exec, -1
L_noep:
    s_lshl_b32 s22, s48, 16
    s_and_b32 s23, s48, s55
    s_lshl_b32 s58, s52, 10
    s_lshl_b32 s61, s41, 1
    s_add_u32 s58, s58, s61
    v_mov_b32 v171, s58
    ds_read_b64 v[160:161], v249 offset:48
    s_lshr_b32 s59, s52, 8
    s_mul_i32 s59, s59, 1280
    s_bfe_u32 s58, s52, 0x20002
    s_mul_i32 s58, s58, 320
    s_add_u32 s59, s59, s58
    s_bfe_u32 s58, s52, 0x40004
    s_and_b32 s60, s52, 3
    s_lshl_b32 s61, s58, 4
    s_add_u32 s59, s59, s61
    s_lshl_b32 s61, s60, 2
    s_add_u32 s59, s59, s61
    v_mov_b32 v172, s59
    s_and_b32 s58, s53, s55
    s_xor_b32 s59, s58, 0x80000000
    s_xor_b32 s60, s58, s55
    s_bitcmp1_b32 s58, 31
    s_cselect_b32 s58, s59, s60
    v_mov_b32 v242, 0xbfb8aa3b
    v_mul_f32 v168, s58, v242
    v_exp_f32 v168, v168
    v_mov_b32 v152, 0
    v_add_f32 v168, 1.0, v168
    v_rcp_f32 v168, v168
    v_mov_b32 v153, 0
    v_cvt_pk_bf16_f32 v168, v168, v168
    v_mov_b32 v154, s43
    v_and_b32 v168, s55, v168
    ds_read_b32 v162, v172 offset:0
    ds_read_b32 v163, v172 offset:10240
    ds_read_b32 v173, v172 offset:20480
    ds_read_b32 v174, v172 offset:30720
    s_cmp_lg_u32 s46, 0
    s_cbranch_scc1 L_c_nob6
    s_barrier
L_c_nob6:
    s_waitcnt lgkmcnt(0)
    v_add_f32 v162, v162, v173
    v_add_f32 v163, v163, v174
    v_cvt_pk_bf16_f32 v240, v162, v163
    v_lshlrev_b32 v162, 16, v240
    v_and_b32 v163, s55, v240
    v_and_b32 v241, s55, v161
    v_lshlrev_b32 v242, 16, v161
    v_rcp_f32 v241, v241
    v_lshlrev_b32 v169, 16, v160
    v_and_b32 v170, s55, v160
    v_sub_f32 v164, v169, v242
    v_sub_f32 v165, v170, v242
    v_cvt_pk_bf16_f32 v240, v164, v165
    v_lshlrev_b32 v164, 16, v240
    v_and_b32 v165, s55, v240
    v_mul_f32 v164, v164, v241
    v_mul_f32 v165, v165, v241
    v_cvt_pk_bf16_f32 v240, v164, v165
    v_lshlrev_b32 v164, 16, v240
    v_and_b32 v165, s55, v240
    v_mul_f32 v166, s22, v164
    v_mul_f32 v167, s23, v165
    v_cvt_pk_bf16_f32 v240, v166, v167
    v_lshlrev_b32 v166, 16, v240
    v_and_b32 v167, s55, v240
    v_add_f32 v162, v162, v166
    v_add_f32 v163, v163, v167
    v_cvt_pk_bf16_f32 v240, v162, v163
    v_lshlrev_b32 v162, 16, v240
    v_and_b32 v163, s55, v240
    global_load_dwordx4 v[144:147], v68, s[36:37] offset:-2048 sc1
    global_load_dwordx4 v[148:151], v68, s[36:37] sc1
    s_mov_b32 exec_hi, 0xfff
    global_load_dwordx4 v[152:155], v68, s[36:37] offset:2048 sc1
    s_mov_b64 exec, -1
    s_mov_b32 s54, 65536
L_ffnspin:
    s_waitcnt vmcnt(0)
    v_xor_b32 v240, s43, v146
    v_xor_b32 v241, s43, v150
    v_xor_b32 v242, s43, v154
    v_or3_b32 v240, v240, v241, v242
    v_cmp_ne_u32 vcc, 0, v240
    s_nop 0
    s_cbranch_vccz L_ffnok
    global_load_dwordx4 v[144:147], v68, s[36:37] offset:-2048 sc1
    global_load_dwordx4 v[148:151], v68, s[36:37] sc1
    s_mov_b32 exec_hi, 0xfff
    global_load_dwordx4 v[152:155], v68, s[36:37] offset:2048 sc1
    s_mov_b64 exec, -1
    s_sub_u32 s54, s54, 1
    s_cmp_lg_u32 s54, 0
    s_cbranch_scc1 L_ffnspin
    s_waitcnt vmcnt(0)
L_ffnok:
    v_add_f32 v144, v144, v148
    v_add_f32 v145, v145, v149
    v_add_f32 v144, v144, v152
    v_add_f32 v145, v145, v153
    s_nop 0
    v_add_f32_dpp v144, v144, v144 row_shr:1 row_mask:0xf bank_mask:0xf
    v_add_f32_dpp v145, v145, v145 row_shr:1 row_mask:0xf bank_mask:0xf
    s_nop 0
    v_add_f32_dpp v144, v144, v144 row_shr:2 row_mask:0xf bank_mask:0xf
    v_add_f32_dpp v145, v145, v145 row_shr:2 row_mask:0xf bank_mask:0xf
    s_nop 0
    v_add_f32_dpp v144, v144, v144 row_shr:4 row_mask:0xf bank_mask:0xf
    v_add_f32_dpp v145, v145, v145 row_shr:4 row_mask:0xf bank_mask:0xf
    s_nop 0
    v_add_f32_dpp v144, v144, v144 row_shr:8 row_mask:0xf bank_mask:0xf
    v_add_f32_dpp v145, v145, v145 row_shr:8 row_mask:0xf bank_mask:0xf
    s_nop 0
    v_add_f32_dpp v144, v144, v144 row_bcast:15 row_mask:0xa bank_mask:0xf
    v_add_f32_dpp v145, v145, v145 row_bcast:15 row_mask:0xa bank_mask:0xf
    s_nop 0
    v_add_f32_dpp v144, v144, v144 row_bcast:31 row_mask:0xc bank_mask:0xf
    v_add_f32_dpp v145, v145, v145 row_bcast:31 row_mask:0xc bank_mask:0xf
    v_cvt_pk_bf16_f32 v240, v144, v145
    v_lshlrev_b32 v144, 16, v240
    v_and_b32 v145, s55, v240
    v_mul_f32 v144, v144, v168
    v_mul_f32 v145, v145, v168
    v_cvt_pk_bf16_f32 v240, v144, v145
    v_lshlrev_b32 v144, 16, v240
    v_and_b32 v145, s55, v240
    v_add_f32 v144, v144, v164
    v_add_f32 v145, v145, v165
    v_cvt_pk_bf16_f32 v240, v144, v145
    v_lshlrev_b32 v144, 16, v240
    v_and_b32 v145, s55, v240
    v_mul_f32 v148, 0xbfb8aa3b, v144
    v_mul_f32 v149, 0xbfb8aa3b, v145
    v_exp_f32 v148, v148
    v_exp_f32 v149, v149
    v_add_f32 v148, 1.0, v148
    v_add_f32 v149, 1.0, v149
    v_rcp_f32 v148, v148
    v_rcp_f32 v149, v149
    v_mul_f32 v144, v144, v148
    v_mul_f32 v145, v145, v149
    v_cvt_pk_bf16_f32 v240, v144, v145
    v_lshlrev_b32 v144, 16, v240
    v_and_b32 v145, s55, v240
    v_mul_f32 v144, v144, v162
    v_mul_f32 v145, v145, v163
    v_cvt_pk_bf16_f32 v240, v144, v145
    v_lshlrev_b32 v144, 16, v240
    v_and_b32 v145, s55, v240
    v_add_f32 v144, v144, v169
    v_add_f32 v145, v145, v170
    v_cvt_pk_bf16_f32 v240, v144, v145
    s_mov_b32 exec_lo, 0
    s_mov_b32 exec_hi, 0x80000000
    global_store_dword v171, v240, s[32:33]
    s_mov_b64 exec, -1
    s_endpgm
L_helper:
    s_lshl_b32 s60, s39, 18
    s_lshl_b32 s61, s40, 13
    s_add_u32 s60, s60, s61
    s_lshl_b32 s61, s45, 11
    s_add_u32 s60, s60, s61
    s_add_u32 s60, s60, 1048576
    v_lshl_add_u32 v13, v1, 4, s60
    s_barrier
    s_lshl_b32 s58, s41, 1
    s_load_dword s48, s[20:21], s58
    s_getreg_b32 s42, hwreg(HW_REG_XCC_ID, 0, 4)
    s_mov_b32 s49, 0x3f803f80
    s_mov_b32 s55, 0xffff0000
    s_mul_i32 s58, s39, 43
    s_lshr_b32 s56, s58, 3
    s_add_u32 s58, s58, 43
    s_lshr_b32 s58, s58, 3
    s_sub_u32 s57, s58, s56
    s_cmp_eq_u32 s45, 0
    s_cselect_b32 s47, 1, 0
    s_lshl_b32 s58, s39, 1
    s_lshl_b32 s6, 0x00030003, s58
    s_mov_b32 s7, s6
    s_lshr_b32 s59, s45, 1
    s_and_b32 s60, s45, 1
    s_lshl_b32 s58, s2, 5
    s_lshl_b32 s61, s59, 4
    s_add_u32 s58, s58, s61
    s_lshl_b32 s61, s60, 13
    s_add_u32 s58, s58, s61
    s_add_u32 s58, s58, 4096
    v_mov_b32 v2, s58
    s_lshl_b32 s58, s2, 3
    s_lshl_b32 s61, s45, 1
    s_add_u32 s58, s58, s61
    s_sub_u32 s58, 0xffff, s58
    v_sub_u32 v3, s58, v244
    s_lshl_b32 s58, s39, 7
    s_lshl_b32 s61, s45, 5
    s_add_u32 s58, s58, s61
    s_add_u32 s58, s58, 24576
    v_and_b32 v240, 7, v1
    v_lshl_add_u32 v230, v240, 2, s58
    s_lshl_b32 s58, s39, 7
    s_lshl_b32 s61, s40, 2
    s_add_u32 s58, s58, s61
    s_add_u32 s58, s58, 24576
    s_lshl_b32 s59, s39, 5
    s_lshl_b32 s61, s45, 11
    s_add_u32 s59, s59, s61
    s_add_u32 s59, s59, 4108
    s_lshl_b32 s60, s45, 11
    s_add_u32 s60, s60, 4096
    v_mov_b32 v11, s58
    v_and_b32 v240, 7, v1
    v_lshl_add_u32 v12, v240, 8, s59
    v_lshl_add_u32 v14, v1, 4, s60
    v_add_u32 v15, 8192, v14
    s_lshl_b32 s58, s45, 19
    s_lshl_b32 s61, s41, 1
    s_add_u32 s58, s58, s61
    s_lshl_b32 s59, s45, 10
    s_add_u32 s59, s59, 92768
    s_lshl_b32 s60, s45, 2
    s_add_u32 s60, s60, 135296
    v_lshl_add_u32 v16, v1, 12, s58
    v_add_u32 v17, 0x40000, v16
    v_lshl_add_u32 v18, v1, 3, s59
    v_mov_b32 v37, s60
    v_mov_b32 v72, 0
    v_mov_b32 v73, 0
    v_mov_b32 v74, 0
    v_mov_b32 v75, 0
    s_setprio 2
    v_mov_b32 v243, 135296
    s_waitcnt vmcnt(3)
    v_dot2_f32_bf16 v72, v40, s49, v72
    v_dot2_f32_bf16 v73, v40, v40, v73
    v_dot2_f32_bf16 v72, v41, s49, v72
    v_dot2_f32_bf16 v73, v41, v41, v73
    v_dot2_f32_bf16 v72, v42, s49, v72
    v_dot2_f32_bf16 v73, v42, v42, v73
    v_dot2_f32_bf16 v72, v43, s49, v72
    v_dot2_f32_bf16 v73, v43, v43, v73
    v_dot2_f32_bf16 v72, v44, s49, v72
    v_dot2_f32_bf16 v73, v44, v44, v73
    v_dot2_f32_bf16 v72, v45, s49, v72
    v_dot2_f32_bf16 v73, v45, v45, v73
    v_dot2_f32_bf16 v72, v46, s49, v72
    v_dot2_f32_bf16 v73, v46, v46, v73
    v_dot2_f32_bf16 v72, v47, s49, v72
    v_dot2_f32_bf16 v73, v47, v47, v73
    s_waitcnt vmcnt(2)
    v_readfirstlane_b32 s43, v35
    s_nop 0
    s_add_u32 s43, s43, 16
    s_and_b32 s43, s43, -16
    s_or_b32 s44, s43, s42
    v_mov_b32 v107, s44
    s_mov_b64 exec, 1
    ds_write_b32 v243, v107 offset:20
    s_mov_b64 exec, -1
    s_waitcnt vmcnt(0)
    v_dot2_f32_bf16 v74, v40, v56, v74
    v_dot2_f32_bf16 v75, v56, s49, v75
    v_dot2_f32_bf16 v74, v41, v57, v74
    v_dot2_f32_bf16 v75, v57, s49, v75
    v_dot2_f32_bf16 v74, v42, v58, v74
    v_dot2_f32_bf16 v75, v58, s49, v75
    v_dot2_f32_bf16 v74, v43, v59, v74
    v_dot2_f32_bf16 v75, v59, s49, v75
    v_dot2_f32_bf16 v74, v44, v60, v74
    v_dot2_f32_bf16 v75, v60, s49, v75
    v_dot2_f32_bf16 v74, v45, v61, v74
    v_dot2_f32_bf16 v75, v61, s49, v75
    v_dot2_f32_bf16 v74, v46, v62, v74
    v_dot2_f32_bf16 v75, v62, s49, v75
    v_dot2_f32_bf16 v74, v47, v63, v74
    v_dot2_f32_bf16 v75, v63, s49, v75
    v_add_f32_dpp v72, v72, v72 row_shr:1 row_mask:0xf bank_mask:0xf
    v_add_f32_dpp v73, v73, v73 row_shr:1 row_mask:0xf bank_mask:0xf
    v_add_f32_dpp v74, v74, v74 row_shr:1 row_mask:0xf bank_mask:0xf
    v_add_f32_dpp v75, v75, v75 row_shr:1 row_mask:0xf bank_mask:0xf
    v_add_f32_dpp v72, v72, v72 row_shr:2 row_mask:0xf bank_mask:0xf
    v_add_f32_dpp v73, v73, v73 row_shr:2 row_mask:0xf bank_mask:0xf
    v_add_f32_dpp v74, v74, v74 row_shr:2 row_mask:0xf bank_mask:0xf
    v_add_f32_dpp v75, v75, v75 row_shr:2 row_mask:0xf bank_mask:0xf
    v_add_f32_dpp v72, v72, v72 row_shr:4 row_mask:0xf bank_mask:0xf
    v_add_f32_dpp v73, v73, v73 row_shr:4 row_mask:0xf bank_mask:0xf
    v_add_f32_dpp v74, v74, v74 row_shr:4 row_mask:0xf bank_mask:0xf
    v_add_f32_dpp v75, v75, v75 row_shr:4 row_mask:0xf bank_mask:0xf
    v_add_f32_dpp v72, v72, v72 row_shr:8 row_mask:0xf bank_mask:0xf
    v_add_f32_dpp v73, v73, v73 row_shr:8 row_mask:0xf bank_mask:0xf
    v_add_f32_dpp v74, v74, v74 row_shr:8 row_mask:0xf bank_mask:0xf
    v_add_f32_dpp v75, v75, v75 row_shr:8 row_mask:0xf bank_mask:0xf
    v_add_f32_dpp v72, v72, v72 row_bcast:15 row_mask:0xa bank_mask:0xf
    v_add_f32_dpp v73, v73, v73 row_bcast:15 row_mask:0xa bank_mask:0xf
    v_add_f32_dpp v74, v74, v74 row_bcast:15 row_mask:0xa bank_mask:0xf
    v_add_f32_dpp v75, v75, v75 row_bcast:15 row_mask:0xa bank_mask:0xf
    v_mul_f32 v72, 0x3b000000, v72
    v_mul_f32 v73, 0x3b000000, v73
    v_fma_f32 v73, -v72, v72, v73
    v_max_f32 v73, 0, v73
    v_cvt_pk_bf16_f32 v240, v72, v73
    v_and_b32 v240, s55, v240
    v_add_f32 v240, 0x3727c5ac, v240
    v_cvt_pk_bf16_f32 v240, v240, v240
    v_and_b32 v240, s55, v240
    v_sqrt_f32 v240, v240
    s_nop 0
    v_cvt_pk_bf16_f32 v105, v72, v240
    v_and_b32 v240, s55, v105
    v_lshlrev_b32 v241, 16, v105
    v_rcp_f32 v240, v240
    v_fma_f32 v74, -v241, v75, v74
    v_readlane_b32 s58, v105, 31
    v_mul_f32 v74, v74, v240
    v_cvt_pk_bf16_f32 v74, v74, v74
    v_mov_b32 v104, s58
    v_ashrrev_i32 v240, 31, v74
    v_or_b32 v240, 0x80000000, v240
    v_xor_b32 v240, v240, v74
    v_and_or_b32 v240, v240, s55, v3
    s_nop 0
    v_readlane_b32 s58, v240, 31
    s_nop 1
    v_max_u32 v106, s58, v240
    s_mov_b32 exec_lo, 0
    s_mov_b32 exec_hi, 0x80000000
    global_store_dwordx4 v2, v[104:107], s[36:37] sc1
    s_mov_b64 exec, -1
    s_cmp_lg_u32 s45, 0
    s_barrier
    s_cbranch_scc1 L_noflag
    s_mov_b64 exec, 1
    global_store_dword v11, v107, s[36:37]
    s_mov_b64 exec, -1
L_noflag:
    s_setprio 0
    s_mul_i32 s58, s45, 2560
    s_lshl_b32 s59, s45, 12
    s_add_u32 s59, s59, 110720
    v_and_b32 v242, 3, v1
    v_lshrrev_b32 v243, 2, v1
    v_mul_u32_u24 v244, 320, v242
    v_lshl_add_u32 v244, v243, 4, v244
    v_add_u32 v19, s58, v244
    v_lshl_add_u32 v242, v242, 3, s59
    v_lshl_add_u32 v26, v243, 7, v242
    v_lshl_add_u32 v27, v1, 4, s59
    s_mul_i32 s58, s39, 24
    s_mul_i32 s59, s45, 6
    s_add_u32 s58, s58, s59
    s_lshl_b32 s58, s58, 12
    s_lshl_b32 s61, s40, 7
    s_add_u32 s58, s58, s61
    s_add_u32 s58, s58, 3145728
    s_lshl_b32 s59, s40, 5
    v_lshrrev_b32 v242, 4, v1
    v_lshl_add_u32 v28, v242, 3, s59
    v_lshrrev_b32 v242, 3, v1
    v_and_b32 v243, 7, v1
    v_lshl_add_u32 v243, v243, 4, s58
    v_lshl_add_u32 v25, v242, 12, v243
    s_mul_i32 s58, s45, 3
    s_lshl_b32 s59, s57, 1
    s_sub_u32 s59, s59, s58
    s_min_u32 s59, s59, 3
    s_lshl_b32 s59, s59, 4
    s_bfm_b64 s[8:9], s59, 0
    s_lshl_b32 s58, s39, 9
    s_lshl_b32 s61, s45, 7
    s_add_u32 s58, s58, s61
    s_lshl_b32 s61, s40, 2
    s_add_u32 s58, s58, s61
    s_add_u32 s58, s58, 28672
    v_mov_b32 v32, s58
    s_lshr_b32 s59, s40, 3
    s_lshl_b32 s58, s39, 9
    s_lshl_b32 s61, s59, 7
    s_add_u32 s58, s58, s61
    s_add_u32 s58, s58, 28672
    v_and_b32 v240, 31, v1
    v_lshl_add_u32 v10, v240, 2, s58
    s_lshl_b32 s58, s57, 2
    s_lshl_b32 s50, s56, 2
    s_add_u32 s50, s50, s40
    s_cmp_lt_u32 s40, s58
    s_cselect_b32 s50, s50, s40
    s_cselect_b32 s51, 1, 0
    s_cselect_b64 s[10:11], -1, 1
    s_lshl_b32 s59, s50, 13
    s_lshl_b32 s61, s45, 8
    s_add_u32 s59, s59, s61
    s_mul_i32 s60, s39, 24
    s_add_u32 s60, s60, s40
    s_lshl_b32 s60, s60, 12
    s_lshl_b32 s61, s45, 10
    s_add_u32 s60, s60, s61
    s_add_u32 s60, s60, 3145728
    v_and_b32 v240, 15, v1
    v_lshrrev_b32 v241, 4, v1
    v_lshl_add_u32 v22, v240, 4, s59
    v_lshl_add_u32 v22, v241, 10, v22
    v_add_u32 v30, 4096, v22
    v_lshl_add_u32 v24, v1, 7, s60
    s_lshl_b32 s59, s45, 12
    s_add_u32 s59, s59, 110720
    s_lshl_b32 s58, s50, 5
    s_add_u32 s58, s58, 65536
    s_lshl_b32 s61, s45, 10
    s_sub_u32 s60, s60, s61
    v_lshl_add_u32 v23, v1, 4, s60
    v_lshl_add_u32 v34, v1, 2, s59
    v_bfe_u32 v244, v0, 1, 7
    v_mul_u32_u24 v244, 6144, v244
    v_and_b32 v243, 1, v1
    v_lshl_add_u32 v244, v243, 4, v244
    v_add_u32 v31, s58, v244
    s_waitcnt lgkmcnt(0)
    s_mov_b32 s54, 65536
L_flagspin:
    global_load_dword v241, v230, s[36:37] sc1
    s_waitcnt vmcnt(0)
    v_cmp_ne_u32 vcc, s44, v241
    s_nop 0
    s_cbranch_vccz L_fast
    s_sub_u32 s54, s54, 1
    s_and_b32 s58, s54, 7
    s_cbranch_scc1 L_flagspin
    global_load_dword v240, v12, s[36:37] sc1
    s_waitcnt vmcnt(0)
    v_xor_b32 v240, s44, v240
    v_add_u32 v240, -1, v240
    v_cmp_gt_u32 vcc, 15, v240
    s_nop 0
    s_cbranch_vccnz L_gather
    s_cmp_lg_u32 s54, 0
    s_cbranch_scc1 L_flagspin
L_gather:
    global_load_dword v40, v16, s[4:5] offset:0
    global_load_dword v41, v16, s[4:5] offset:1024
    global_load_dword v42, v16, s[4:5] offset:2048
    global_load_dword v43, v16, s[4:5] offset:3072
    global_load_dword v44, v17, s[4:5] offset:0
    global_load_dword v45, v17, s[4:5] offset:1024
    global_load_dword v46, v17, s[4:5] offset:2048
    global_load_dword v47, v17, s[4:5] offset:3072
    s_branch L_stats
L_fast:
    global_load_dwordx4 v[40:43], v13, s[36:37] sc1
    global_load_dwordx4 v[44:47], v13, s[36:37] offset:1024 sc1
L_stats:
    global_load_dwordx4 v[56:59], v14, s[36:37] offset:0 sc1
    global_load_dwordx4 v[60:63], v15, s[36:37] offset:0 sc1
    global_load_dwordx4 v[64:67], v14, s[36:37] offset:1024 sc1
    global_load_dwordx4 v[68:71], v15, s[36:37] offset:1024 sc1
    s_lshl_b32 s58, s45, 11
    s_add_u32 s58, s58, 127104
    s_lshl_b32 s59, s39, 18
    s_lshl_b32 s61, s40, 8
    s_add_u32 s59, s59, s61
    s_lshl_b32 s61, s45, 6
    s_add_u32 s59, s59, s61
    s_add_u32 s59, s59, 1048576
    v_lshrrev_b32 v240, 3, v1
    v_and_b32 v241, 7, v1
    v_lshrrev_b32 v242, 5, v1
    v_lshlrev_b32 v242, 1, v242
    v_xor_b32 v242, v242, v241
    v_lshl_add_u32 v242, v242, 4, s58
    v_lshl_add_u32 v4, v240, 7, v242
    v_xor_b32 v5, 64, v4
    v_and_b32 v240, 3, v1
    v_lshrrev_b32 v241, 4, v1
    v_lshlrev_b32 v242, 1, v240
    v_xor_b32 v241, v241, v242
    v_lshl_add_u32 v241, v241, 4, s58
    v_lshl_add_u32 v241, v240, 9, v241
    v_bfe_u32 v242, v1, 2, 2
    v_lshl_add_u32 v6, v242, 2, v241
    v_xor_b32 v7, 64, v6
    v_lshl_add_u32 v240, v240, 4, s59
    v_lshrrev_b32 v241, 2, v1
    v_lshl_add_u32 v8, v241, 13, v240
    v_add_u32 v9, 0x20000, v8
    s_lshl_b32 s58, s40, 16
    s_lshl_b32 s61, s45, 14
    s_add_u32 s58, s58, s61
    s_lshl_b32 s61, s39, 7
    s_add_u32 s58, s58, s61
    v_lshrrev_b32 v246, 3, v1
    v_and_b32 v247, 7, v1
    v_lshl_add_u32 v247, v247, 4, s58
    v_lshl_add_u32 v20, v246, 10, v247
    v_add_u32 v21, 8192, v20
    s_mov_b64 exec, s[10:11]
    global_load_dwordx4 v[144:147], v22, s[30:31]
    global_load_dwordx4 v[148:151], v30, s[30:31]
    s_and_b64 exec, s[10:11], 0xff
    global_load_dword v36, v24, s[36:37] nt
    s_mov_b64 exec, 1
    global_load_dword v35, v10, s[36:37] sc1
    s_mov_b64 exec, -1
    s_waitcnt vmcnt(4)
    s_mov_b32 s54, 65536
L_statspin:
    v_xor_b32 v240, s43, v59
    v_xor_b32 v241, s43, v63
    v_xor_b32 v242, s43, v67
    v_xor_b32 v243, s43, v71
    v_or3_b32 v241, v240, v241, v243
    v_or_b32 v241, v241, v242
    v_cmp_lt_u32 vcc, 15, v241
    s_nop 0
    s_cbranch_vccz L_statok
    global_load_dwordx4 v[56:59], v14, s[36:37] offset:0 sc1
    global_load_dwordx4 v[60:63], v15, s[36:37] offset:0 sc1
    global_load_dwordx4 v[64:67], v14, s[36:37] offset:1024 sc1
    global_load_dwordx4 v[68:71], v15, s[36:37] offset:1024 sc1
    s_waitcnt vmcnt(0)
    s_sub_u32 s54, s54, 1
    s_cmp_lg_u32 s54, 0
    s_cbranch_scc1 L_statspin
L_statok:
    v_cmp_ne_u32 vcc, s42, v240
    v_cmp_ne_u32 s[60:61], s42, v242
    v_max3_u32 v248, v58, v62, v66
    s_or_b64 vcc, vcc, s[60:61]
    s_and_b64 vcc, vcc, s[6:7]
    v_max_u32 v248, v248, v70
    s_cbranch_vccz L_local
    v_mov_b32 v240, 135296
    v_mov_b32 v241, 1
    ds_write_b32 v240, v241 offset:16
L_local:
    v_and_b32 v241, s55, v56
    v_and_b32 v243, s55, v57
    v_and_b32 v245, s55, v60
    v_and_b32 v247, s55, v61
    v_rcp_f32 v241, v241
    v_lshlrev_b32 v240, 16, v56
    v_rcp_f32 v243, v243
    v_lshlrev_b32 v242, 16, v57
    v_rcp_f32 v245, v245
    v_lshlrev_b32 v244, 16, v60
    v_rcp_f32 v247, v247
    v_lshlrev_b32 v246, 16, v61
    v_mul_f32_e64 v240, -v240, v241
    v_lshlrev_b32 v72, 16, v40
    v_and_b32 v73, s55, v40
    v_max_u32_dpp v248, v248, v248 row_shr:1 row_mask:0xf bank_mask:0xf
    v_fma_f32 v88, v72, v241, v240
    v_fma_f32 v89, v73, v241, v240
    v_mul_f32_e64 v242, -v242, v243
    v_lshlrev_b32 v74, 16, v41
    v_and_b32 v75, s55, v41
    v_max_u32_dpp v248, v248, v248 row_shr:2 row_mask:0xf bank_mask:0xf
    v_fma_f32 v90, v74, v243, v242
    v_fma_f32 v91, v75, v243, v242
    v_mul_f32_e64 v244, -v244, v245
    v_lshlrev_b32 v76, 16, v42
    v_and_b32 v77, s55, v42
    v_max_u32_dpp v248, v248, v248 row_shr:4 row_mask:0xf bank_mask:0xf
    v_fma_f32 v92, v76, v245, v244
    v_fma_f32 v93, v77, v245, v244
    v_mul_f32_e64 v246, -v246, v247
    v_lshlrev_b32 v78, 16, v43
    v_and_b32 v79, s55, v43
    v_fma_f32 v94, v78, v247, v246
    v_fma_f32 v95, v79, v247, v246
    v_cvt_pk_bf16_f32 v120, v88, v90
    v_cvt_pk_bf16_f32 v121, v92, v94
    v_cvt_pk_bf16_f32 v122, v89, v91
    v_cvt_pk_bf16_f32 v123, v93, v95
    ds_write_b64 v18, v[120:121] offset:0
    ds_write_b64 v18, v[122:123] offset:4576
    v_and_b32 v241, s55, v64
    v_and_b32 v243, s55, v65
    v_and_b32 v245, s55, v68
    v_and_b32 v247, s55, v69
    v_rcp_f32 v241, v241
    v_lshlrev_b32 v240, 16, v64
    v_rcp_f32 v243, v243
    v_lshlrev_b32 v242, 16, v65
    v_rcp_f32 v245, v245
    v_lshlrev_b32 v244, 16, v68
    v_rcp_f32 v247, v247
    v_lshlrev_b32 v246, 16, v69
    v_mul_f32_e64 v240, -v240, v241
    v_lshlrev_b32 v80, 16, v44
    v_and_b32 v81, s55, v44
    v_max_u32_dpp v248, v248, v248 row_shr:8 row_mask:0xf bank_mask:0xf
    v_fma_f32 v96, v80, v241, v240
    v_fma_f32 v97, v81, v241, v240
    v_mul_f32_e64 v242, -v242, v243
    v_lshlrev_b32 v82, 16, v45
    v_and_b32 v83, s55, v45
    v_max_u32_dpp v248, v248, v248 row_bcast:15 row_mask:0xa bank_mask:0xf
    v_fma_f32 v98, v82, v243, v242
    v_fma_f32 v99, v83, v243, v242
    v_mul_f32_e64 v244, -v244, v245
    v_lshlrev_b32 v84, 16, v46
    v_and_b32 v85, s55, v46
    v_max_u32_dpp v248, v248, v248 row_bcast:31 row_mask:0xc bank_mask:0xf
    v_fma_f32 v100, v84, v245, v244
    v_fma_f32 v101, v85, v245, v244
    v_mul_f32_e64 v246, -v246, v247
    v_lshlrev_b32 v86, 16, v47
    v_and_b32 v87, s55, v47
    v_fma_f32 v102, v86, v247, v246
    v_fma_f32 v103, v87, v247, v246
    v_cvt_pk_bf16_f32 v124, v96, v98
    v_cvt_pk_bf16_f32 v125, v100, v102
    v_cvt_pk_bf16_f32 v126, v97, v99
    v_cvt_pk_bf16_f32 v127, v101, v103
    ds_write_b64 v18, v[124:125] offset:512
    ds_write_b64 v18, v[126:127] offset:5088
    s_mov_b32 exec_lo, 0
    s_mov_b32 exec_hi, 0x80000000
    ds_write_b32 v37, v248
    s_mov_b64 exec, -1
    s_waitcnt lgkmcnt(0)
    s_barrier
    s_setprio 2
    v_mov_b32 v249, 135296
    ds_read_b128 v[240:243], v249
    ds_read_b64 v[244:245], v249 offset:16
    s_waitcnt lgkmcnt(0)
    v_max3_u32 v240, v240, v241, v242
    v_readfirstlane_b32 s46, v244
    v_max_u32 v240, v240, v243
    v_readfirstlane_b32 s44, v245
    v_readfirstlane_b32 s53, v240
    s_nop 0
    s_andn2_b32 s52, 2047, s53
    s_lshl_b32 s58, s52, 10
    v_add_u32 v240, s58, v28
    s_lshr_b32 s58, s52, 2
    s_bfe_u32 s59, s52, 0x10001
    s_and_b32 s60, s52, 1
    s_lshl_b32 s58, s58, 4
    s_lshl_b32 s61, s59, 13
    s_add_u32 s58, s58, s61
    s_lshl_b32 s61, s60, 2
    s_add_u32 s58, s58, s61
    s_add_u32 s58, s58, 4096
    v_mov_b32 v241, s58
    global_load_dwordx2 v[204:205], v240, s[4:5]
    global_load_dword v211, v241, s[36:37] sc1
    s_lshl_b32 s58, s52, 10
    s_lshl_b32 s61, s41, 1
    s_add_u32 s58, s58, s61
    v_mov_b32 v242, s58
    s_mov_b64 exec, 1
    global_load_dword v210, v242, s[4:5]
    s_mov_b64 exec, -1
    ds_read_b64_tr_b16 v[168:169], v26 offset:0
    ds_read_b64_tr_b16 v[170:171], v26 offset:32
    ds_read_b64_tr_b16 v[172:173], v26 offset:64
    ds_read_b64_tr_b16 v[174:175], v26 offset:2048
    ds_read_b64_tr_b16 v[176:177], v26 offset:2080
    ds_read_b64_tr_b16 v[178:179], v26 offset:2112
    s_setprio 0
L_h_pre:
    s_lshl_b32 s22, s48, 16
    s_and_b32 s23, s48, s55
    s_setprio 2
    s_waitcnt vmcnt(0)
    s_mov_b64 exec, 1
    ds_write_b64 v249, v[210:211] offset:48
    s_mov_b64 exec, -1
    v_and_b32 v252, s55, v211
    v_lshlrev_b32 v254, 16, v211
    v_rcp_f32 v252, v252
    v_lshlrev_b32 v248, 16, v204
    v_and_b32 v249, s55, v204
    v_lshlrev_b32 v250, 16, v205
    v_and_b32 v251, s55, v205
    v_sub_f32 v248, v248, v254
    v_sub_f32 v249, v249, v254
    v_sub_f32 v250, v250, v254
    v_sub_f32 v251, v251, v254
    v_cvt_pk_bf16_f32 v241, v248, v249
    v_lshlrev_b32 v248, 16, v241
    v_and_b32 v249, s55, v241
    v_cvt_pk_bf16_f32 v242, v250, v251
    v_lshlrev_b32 v250, 16, v242
    v_and_b32 v251, s55, v242
    v_mul_f32 v248, v248, v252
    v_mul_f32 v249, v249, v252
    v_mul_f32 v250, v250, v252
    v_mul_f32 v251, v251, v252
    v_cvt_pk_bf16_f32 v200, v248, v249
    v_cvt_pk_bf16_f32 v201, v250, v251
    v_mov_b32 v246, s43
    v_mov_b32 v247, 0
    s_waitcnt lgkmcnt(0)
    v_mfma_f32_16x16x16_bf16 v[184:187], v[200:201], v[168:169], 0
    v_mfma_f32_16x16x16_bf16 v[188:191], v[200:201], v[170:171], 0
    v_mfma_f32_16x16x16_bf16 v[192:195], v[200:201], v[172:173], 0
    v_mfma_f32_16x16x16_bf16 v[196:199], v[200:201], v[174:175], 0
    v_mfma_f32_16x16x16_bf16 v[228:231], v[200:201], v[176:177], 0
    v_mfma_f32_16x16x16_bf16 v[232:235], v[200:201], v[178:179], 0
    s_cmp_eq_u32 s46, 0
    s_nop 1
    v_mov_b32 v244, v184
    s_nop 1
    v_mov_b32 v245, v196
    v_mov_b32_dpp v244, v188 quad_perm:[0,1,2,3] row_mask:0x2 bank_mask:0xf
    v_mov_b32_dpp v245, v228 quad_perm:[0,1,2,3] row_mask:0x2 bank_mask:0xf
    v_mov_b32_dpp v244, v192 quad_perm:[0,1,2,3] row_mask:0x4 bank_mask:0xf
    v_mov_b32_dpp v245, v232 quad_perm:[0,1,2,3] row_mask:0x4 bank_mask:0xf
    s_mov_b64 exec, s[8:9]
    s_cbranch_scc0 L_p1far
    global_store_dwordx4 v25, v[244:247], s[36:37]
    s_branch L_p1done
L_p1far:
    global_store_dwordx4 v25, v[244:247], s[36:37] sc1
L_p1done:
    s_mov_b64 exec, -1
    s_cmp_eq_u32 s51, 0
    s_cbranch_scc1 L_h_ge
    global_load_dwordx4 v[128:131], v23, s[36:37] offset:0 sc1
    global_load_dwordx4 v[132:135], v23, s[36:37] offset:1024 sc1
    global_load_dwordx4 v[136:139], v23, s[36:37] offset:2048 sc1
    global_load_dwordx4 v[140:143], v23, s[36:37] offset:3072 sc1
    s_waitcnt vmcnt(7)
    ds_write_b128 v27, v[144:147]
    ds_write_b128 v27, v[148:151] offset:1024
    ds_read2st64_b32 v[144:145], v34 offset0:0 offset1:1
    ds_read2st64_b32 v[146:147], v34 offset0:2 offset1:3
    ds_read2st64_b32 v[148:149], v34 offset0:4 offset1:5
    ds_read2st64_b32 v[150:151], v34 offset0:6 offset1:7
    s_waitcnt lgkmcnt(0)
    v_mov_b32 v246, s43
    v_mov_b32 v247, 0
    v_lshlrev_b32 v152, 16, v144
    v_and_b32 v153, s55, v144
    v_lshlrev_b32 v154, 16, v145
    v_and_b32 v155, s55, v145
    v_lshlrev_b32 v156, 16, v146
    v_and_b32 v157, s55, v146
    v_lshlrev_b32 v158, 16, v147
    v_and_b32 v159, s55, v147
    v_lshlrev_b32 v160, 16, v148
    v_and_b32 v161, s55, v148
    v_lshlrev_b32 v162, 16, v149
    v_and_b32 v163, s55, v149
    v_lshlrev_b32 v164, 16, v150
    v_and_b32 v165, s55, v150
    v_lshlrev_b32 v166, 16, v151
    v_and_b32 v167, s55, v151
    s_mov_b32 s54, 65536
L_hspin:
    s_waitcnt vmcnt(0)
    v_xor_b32 v248, s43, v130
    v_xor_b32 v249, s43, v134
    v_xor_b32 v250, s43, v138
    v_xor_b32 v251, s43, v142
    v_add_f32 v240, v128, v132
    v_add_f32 v241, v129, v133
    v_or3_b32 v248, v248, v249, v250
    v_add_f32 v242, v136, v140
    v_add_f32 v243, v137, v141
    v_or_b32 v248, v248, v251
    v_add_f32 v240, v240, v242
    v_add_f32 v241, v241, v243
    v_cmp_ne_u32 vcc, 0, v248
    s_nop 0
    s_cbranch_vccz L_hok
    global_load_dwordx4 v[128:131], v23, s[36:37] offset:0 sc1
    global_load_dwordx4 v[132:135], v23, s[36:37] offset:1024 sc1
    global_load_dwordx4 v[136:139], v23, s[36:37] offset:2048 sc1
    global_load_dwordx4 v[140:143], v23, s[36:37] offset:3072 sc1
    s_sub_u32 s54, s54, 1
    s_cmp_lg_u32 s54, 0
    s_cbranch_scc1 L_hspin
    s_waitcnt vmcnt(0)
L_hok:
    v_add_f32_dpp v240, v240, v240 row_ror:8 row_mask:0xf bank_mask:0xf
    v_add_f32_dpp v241, v241, v241 row_ror:8 row_mask:0xf bank_mask:0xf
    v_mov_b32 v242, v240
    v_mov_b32 v243, v241
    s_nop 0
    v_permlane16_swap_b32 v240, v242
    v_permlane16_swap_b32 v241, v243
    v_add_f32 v240, v240, v242
    v_add_f32 v241, v241, v243
    v_mov_b32 v242, v240
    v_mov_b32 v243, v241
    s_nop 0
    v_permlane32_swap_b32 v240, v242
    v_permlane32_swap_b32 v241, v243
    v_add_f32 v240, v240, v242
    v_add_f32 v241, v241, v243
    v_cvt_pk_bf16_f32 v242, v240, v241
    v_lshlrev_b32 v240, 16, v242
    v_mul_f32 v241, 0xbfb8aa3b, v240
    v_exp_f32 v241, v241
    v_and_b32 v242, s55, v242
    v_add_f32 v241, 1.0, v241
    v_rcp_f32 v241, v241
    s_nop 0
    v_mul_f32 v241, v240, v241
    v_cvt_pk_bf16_f32 v241, v241, v241
    v_and_b32 v241, s55, v241
    v_mul_f32 v241, v241, v242
    v_cvt_pk_bf16_f32 v241, v241, v241
    v_and_b32 v241, s55, v241
    s_nop 1
    v_mul_f32_dpp v244, v241, v152 row_newbcast:0 row_mask:0xf bank_mask:0xf
    v_mul_f32_dpp v245, v241, v153 row_newbcast:0 row_mask:0xf bank_mask:0xf
    v_fmac_f32_dpp v244, v241, v154 row_newbcast:1 row_mask:0xf bank_mask:0xf
    v_fmac_f32_dpp v245, v241, v155 row_newbcast:1 row_mask:0xf bank_mask:0xf
    v_fmac_f32_dpp v244, v241, v156 row_newbcast:2 row_mask:0xf bank_mask:0xf
    v_fmac_f32_dpp v245, v241, v157 row_newbcast:2 row_mask:0xf bank_mask:0xf
    v_fmac_f32_dpp v244, v241, v158 row_newbcast:3 row_mask:0xf bank_mask:0xf
    v_fmac_f32_dpp v245, v241, v159 row_newbcast:3 row_mask:0xf bank_mask:0xf
    v_fmac_f32_dpp v244, v241, v160 row_newbcast:4 row_mask:0xf bank_mask:0xf
    v_fmac_f32_dpp v245, v241, v161 row_newbcast:4 row_mask:0xf bank_mask:0xf
    v_fmac_f32_dpp v244, v241, v162 row_newbcast:5 row_mask:0xf bank_mask:0xf
    v_fmac_f32_dpp v245, v241, v163 row_newbcast:5 row_mask:0xf bank_mask:0xf
    v_fmac_f32_dpp v244, v241, v164 row_newbcast:6 row_mask:0xf bank_mask:0xf
    v_fmac_f32_dpp v245, v241, v165 row_newbcast:6 row_mask:0xf bank_mask:0xf
    v_fmac_f32_dpp v244, v241, v166 row_newbcast:7 row_mask:0xf bank_mask:0xf
    v_fmac_f32_dpp v245, v241, v167 row_newbcast:7 row_mask:0xf bank_mask:0xf
    global_store_dwordx4 v31, v[244:247], s[36:37] sc1
L_h_ge:
    s_setprio 0
    v_mul_f32 v206, 0xbfb8aa3b, v88
    v_mul_f32 v207, 0xbfb8aa3b, v89
    v_mul_f32 v208, 0xbfb8aa3b, v90
    v_mul_f32 v209, 0xbfb8aa3b, v91
    v_exp_f32 v206, v206
    v_exp_f32 v207, v207
    v_exp_f32 v208, v208
    v_exp_f32 v209, v209
    v_mul_f32 v104, s22, v88
    v_add_f32 v206, 1.0, v206
    v_mul_f32 v105, s23, v89
    v_add_f32 v207, 1.0, v207
    v_mul_f32 v106, s22, v90
    v_add_f32 v208, 1.0, v208
    v_mul_f32 v107, s23, v91
    v_add_f32 v209, 1.0, v209
    v_rcp_f32 v206, v206
    v_rcp_f32 v207, v207
    v_rcp_f32 v208, v208
    v_rcp_f32 v209, v209
    v_mul_f32 v88, v88, v206
    v_mul_f32 v89, v89, v207
    v_mul_f32 v90, v90, v208
    v_mul_f32 v91, v91, v209
    v_fma_f32 v104, v104, v88, v72
    v_fma_f32 v105, v105, v89, v73
    v_fma_f32 v106, v106, v90, v74
    v_fma_f32 v107, v107, v91, v75
    v_mul_f32 v206, 0xbfb8aa3b, v92
    v_mul_f32 v207, 0xbfb8aa3b, v93
    v_mul_f32 v208, 0xbfb8aa3b, v94
    v_mul_f32 v209, 0xbfb8aa3b, v95
    v_exp_f32 v206, v206
    v_exp_f32 v207, v207
    v_exp_f32 v208, v208
    v_exp_f32 v209, v209
    v_mul_f32 v108, s22, v92
    v_add_f32 v206, 1.0, v206
    v_mul_f32 v109, s23, v93
    v_add_f32 v207, 1.0, v207
    v_mul_f32 v110, s22, v94
    v_add_f32 v208, 1.0, v208
    v_mul_f32 v111, s23, v95
    v_add_f32 v209, 1.0, v209
    v_rcp_f32 v206, v206
    v_rcp_f32 v207, v207
    v_rcp_f32 v208, v208
    v_rcp_f32 v209, v209
    v_mul_f32 v92, v92, v206
    v_mul_f32 v93, v93, v207
    v_mul_f32 v94, v94, v208
    v_mul_f32 v95, v95, v209
    v_fma_f32 v108, v108, v92, v76
    v_fma_f32 v109, v109, v93, v77
    v_fma_f32 v110, v110, v94, v78
    v_fma_f32 v111, v111, v95, v79
    v_mul_f32 v206, 0xbfb8aa3b, v96
    v_mul_f32 v207, 0xbfb8aa3b, v97
    v_mul_f32 v208, 0xbfb8aa3b, v98
    v_mul_f32 v209, 0xbfb8aa3b, v99
    v_exp_f32 v206, v206
    v_exp_f32 v207, v207
    v_exp_f32 v208, v208
    v_exp_f32 v209, v209
    v_mul_f32 v112, s22, v96
    v_add_f32 v206, 1.0, v206
    v_mul_f32 v113, s23, v97
    v_add_f32 v207, 1.0, v207
    v_mul_f32 v114, s22, v98
    v_add_f32 v208, 1.0, v208
    v_mul_f32 v115, s23, v99
    v_add_f32 v209, 1.0, v209
    v_rcp_f32 v206, v206
    v_rcp_f32 v207, v207
    v_rcp_f32 v208, v208
    v_rcp_f32 v209, v209
    v_mul_f32 v96, v96, v206
    v_mul_f32 v97, v97, v207
    v_mul_f32 v98, v98, v208
    v_mul_f32 v99, v99, v209
    v_fma_f32 v112, v112, v96, v80
    v_fma_f32 v113, v113, v97, v81
    v_fma_f32 v114, v114, v98, v82
    v_fma_f32 v115, v115, v99, v83
    v_mul_f32 v206, 0xbfb8aa3b, v100
    v_mul_f32 v207, 0xbfb8aa3b, v101
    v_mul_f32 v208, 0xbfb8aa3b, v102
    v_mul_f32 v209, 0xbfb8aa3b, v103
    v_exp_f32 v206, v206
    v_exp_f32 v207, v207
    v_exp_f32 v208, v208
    v_exp_f32 v209, v209
    v_mul_f32 v116, s22, v100
    v_add_f32 v206, 1.0, v206
    v_mul_f32 v117, s23, v101
    v_add_f32 v207, 1.0, v207
    v_mul_f32 v118, s22, v102
    v_add_f32 v208, 1.0, v208
    v_mul_f32 v119, s23, v103
    v_add_f32 v209, 1.0, v209
    v_rcp_f32 v206, v206
    v_rcp_f32 v207, v207
    v_rcp_f32 v208, v208
    v_rcp_f32 v209, v209
    v_mul_f32 v100, v100, v206
    v_mul_f32 v101, v101, v207
    v_mul_f32 v102, v102, v208
    v_mul_f32 v103, v103, v209
    v_fma_f32 v116, v116, v100, v84
    v_fma_f32 v117, v117, v101, v85
    v_fma_f32 v118, v118, v102, v86
    v_fma_f32 v119, v119, v103, v87
    ds_read2_b32 v[64:65], v6 offset0:0 offset1:32
    ds_read2_b32 v[66:67], v6 offset0:64 offset1:96
    ds_read2_b32 v[68:69], v7 offset0:0 offset1:32
    ds_read2_b32 v[70:71], v7 offset0:64 offset1:96
    s_barrier
    ds_read_b128 v[168:171], v19 offset:0
    ds_read_b128 v[172:175], v19 offset:10240
    ds_read_b128 v[176:179], v19 offset:20480
    ds_read_b128 v[180:183], v19 offset:30720
    ds_read_b128 v[184:187], v19 offset:1280
    ds_read_b128 v[188:191], v19 offset:11520
    ds_read_b128 v[192:195], v19 offset:21760
    ds_read_b128 v[196:199], v19 offset:32000
    s_cmp_lg_u32 s46, 0
    s_cbranch_scc1 L_h_direct
    s_waitcnt lgkmcnt(4)
    v_fma_f32 v104, v168, v88, v104
    v_fma_f32 v105, v172, v89, v105
    v_fma_f32 v106, v169, v90, v106
    v_fma_f32 v107, v173, v91, v107
    v_fma_f32 v108, v170, v92, v108
    v_fma_f32 v109, v174, v93, v109
    v_fma_f32 v110, v171, v94, v110
    v_fma_f32 v111, v175, v95, v111
    v_fma_f32 v104, v176, v88, v104
    v_fma_f32 v105, v180, v89, v105
    v_fma_f32 v106, v177, v90, v106
    v_fma_f32 v107, v181, v91, v107
    v_fma_f32 v108, v178, v92, v108
    v_fma_f32 v109, v182, v93, v109
    v_fma_f32 v110, v179, v94, v110
    v_fma_f32 v111, v183, v95, v111
    v_cvt_pk_bf16_f32 v40, v104, v105
    v_cvt_pk_bf16_f32 v41, v106, v107
    v_cvt_pk_bf16_f32 v42, v108, v109
    v_cvt_pk_bf16_f32 v43, v110, v111
    v_not_b32 v40, v40
    v_not_b32 v41, v41
    v_not_b32 v42, v42
    v_not_b32 v43, v43
    global_store_dwordx4 v13, v[40:43], s[36:37] offset:0
    s_waitcnt lgkmcnt(0)
    v_fma_f32 v112, v184, v96, v112
    v_fma_f32 v113, v188, v97, v113
    v_fma_f32 v114, v185, v98, v114
    v_fma_f32 v115, v189, v99, v115
    v_fma_f32 v116, v186, v100, v116
    v_fma_f32 v117, v190, v101, v117
    v_fma_f32 v118, v187, v102, v118
    v_fma_f32 v119, v191, v103, v119
    v_fma_f32 v112, v192, v96, v112
    v_fma_f32 v113, v196, v97, v113
    v_fma_f32 v114, v193, v98, v114
    v_fma_f32 v115, v197, v99, v115
    v_fma_f32 v116, v194, v100, v116
    v_fma_f32 v117, v198, v101, v117
    v_fma_f32 v118, v195, v102, v118
    v_fma_f32 v119, v199, v103, v119
    v_cvt_pk_bf16_f32 v44, v112, v113
    v_cvt_pk_bf16_f32 v45, v114, v115
    v_cvt_pk_bf16_f32 v46, v116, v117
    v_cvt_pk_bf16_f32 v47, v118, v119
    v_not_b32 v44, v44
    v_not_b32 v45, v45
    v_not_b32 v46, v46
    v_not_b32 v47, v47
    global_store_dwordx4 v13, v[44:47], s[36:37] offset:1024
    s_barrier
    s_lshl_b32 s58, s40, 6
    s_lshl_b32 s61, s45, 4
    s_add_u32 s58, s58, s61
    s_sub_u32 s58, s52, s58
    s_lshl_b32 s59, s58, 3
    s_lshl_b64 s[60:61], 0xff, s59
    s_not_b64 s[60:61], s[60:61]
    s_lshr_b32 s58, s58, 3
    s_cmp_eq_u32 s58, 0
    s_cselect_b64 s[12:13], s[60:61], -1
    s_cmp_eq_u32 s58, 1
    s_cselect_b64 s[14:15], s[60:61], -1
    global_load_dwordx4 v[56:59], v8, s[36:37] sc1
    global_load_dwordx4 v[60:63], v9, s[36:37] sc1
    v_mov_b32 v240, s44
    s_mov_b64 exec, 1
    s_waitcnt vmcnt(2)
    global_store_dword v32, v240, s[36:37]
    s_mov_b64 exec, -1
    s_waitcnt vmcnt(1)
    s_mov_b32 s54, 65536
L_dspin:
    v_xor_b32 v240, v56, v64
    v_xor_b32 v241, v57, v65
    v_xor_b32 v242, v58, v66
    v_xor_b32 v243, v59, v67
    v_xor_b32 v244, v60, v68
    v_xor_b32 v245, v61, v69
    v_xor_b32 v246, v62, v70
    v_xor_b32 v247, v63, v71
    v_min3_u32 v240, v240, v241, v242
    v_min3_u32 v243, v243, v244, v245
    v_min3_u32 v240, v240, v246, v247
    v_min_u32 v240, v240, v243
    v_cmp_eq_u32 vcc, 0, v240
    s_nop 0
    s_cbranch_vccz L_dok
    s_sub_u32 s54, s54, 1
    s_and_b32 s58, s54, 7
    s_cbranch_scc1 L_dmore
    global_load_dword v240, v10, s[36:37] sc1
    s_waitcnt vmcnt(0)
    v_cmp_ne_u32 vcc, s44, v240
    s_nop 0
    s_cbranch_vccz L_dlast
    s_cmp_eq_u32 s54, 0
    s_cbranch_scc1 L_dlast
L_dmore:
    global_load_dwordx4 v[56:59], v8, s[36:37] sc1
    global_load_dwordx4 v[60:63], v9, s[36:37] sc1
    s_waitcnt vmcnt(0)
    s_branch L_dspin
L_dlast:
    global_load_dwordx4 v[56:59], v8, s[36:37] sc1
    global_load_dwordx4 v[60:63], v9, s[36:37] sc1
    s_waitcnt vmcnt(0)
L_dok:
    v_not_b32 v56, v56
    v_not_b32 v57, v57
    v_not_b32 v58, v58
    v_not_b32 v59, v59
    v_not_b32 v60, v60
    v_not_b32 v61, v61
    v_not_b32 v62, v62
    v_not_b32 v63, v63
    v_mov_b32 v241, 135296
    s_mov_b64 exec, 1
    ds_write_b32 v241, v241 offset:40
    s_mov_b64 exec, -1
    ds_write2_b32 v6, v56, v57 offset0:0 offset1:32
    ds_write2_b32 v6, v58, v59 offset0:64 offset1:96
    ds_write2_b32 v7, v60, v61 offset0:0 offset1:32
    ds_write2_b32 v7, v62, v63 offset0:64 offset1:96
    ds_read_b128 v[48:51], v4
    ds_read_b128 v[52:55], v5 offset:1024
    s_mov_b64 exec, s[12:13]
    s_waitcnt lgkmcnt(1)
    global_store_dwordx4 v20, v[48:51], s[32:33]
    s_mov_b64 exec, s[14:15]
    s_waitcnt lgkmcnt(0)
    global_store_dwordx4 v21, v[52:55], s[32:33]
    s_mov_b64 exec, -1
    s_branch L_h_done
L_h_direct:
    s_lshr_b32 s58, s52, 2
    s_lshl_b64 s[60:61], 1, s58
    s_not_b64 s[60:61], s[60:61]
    s_lshr_b32 s58, s52, 8
    s_lshl_b32 s58, s58, 2
    s_and_b32 s59, s52, 3
    s_add_u32 s58, s58, s59
    s_lshl_b32 s59, s45, 3
    s_sub_u32 s58, s58, s59
    s_waitcnt lgkmcnt(4)
    v_fma_f32 v104, v168, v88, v104
    v_fma_f32 v105, v172, v89, v105
    v_fma_f32 v106, v169, v90, v106
    v_fma_f32 v107, v173, v91, v107
    v_fma_f32 v108, v170, v92, v108
    v_fma_f32 v109, v174, v93, v109
    v_fma_f32 v110, v171, v94, v110
    v_fma_f32 v111, v175, v95, v111
    v_fma_f32 v104, v176, v88, v104
    v_fma_f32 v105, v180, v89, v105
    v_fma_f32 v106, v177, v90, v106
    v_fma_f32 v107, v181, v91, v107
    v_fma_f32 v108, v178, v92, v108
    v_fma_f32 v109, v182, v93, v109
    v_fma_f32 v110, v179, v94, v110
    v_fma_f32 v111, v183, v95, v111
    v_cvt_pk_bf16_f32 v40, v104, v105
    v_cvt_pk_bf16_f32 v41, v106, v107
    v_cvt_pk_bf16_f32 v42, v108, v109
    v_cvt_pk_bf16_f32 v43, v110, v111
    s_cmp_eq_u32 s58, 0
    s_cselect_b64 exec, s[60:61], -1
    global_store_dword v16, v40, s[32:33] offset:0
    s_cmp_eq_u32 s58, 1
    s_cselect_b64 exec, s[60:61], -1
    global_store_dword v16, v41, s[32:33] offset:1024
    s_cmp_eq_u32 s58, 2
    s_cselect_b64 exec, s[60:61], -1
    global_store_dword v16, v42, s[32:33] offset:2048
    s_cmp_eq_u32 s58, 3
    s_cselect_b64 exec, s[60:61], -1
    global_store_dword v16, v43, s[32:33] offset:3072
    s_mov_b64 exec, -1
    s_waitcnt lgkmcnt(0)
    v_fma_f32 v112, v184, v96, v112
    v_fma_f32 v113, v188, v97, v113
    v_fma_f32 v114, v185, v98, v114
    v_fma_f32 v115, v189, v99, v115
    v_fma_f32 v116, v186, v100, v116
    v_fma_f32 v117, v190, v101, v117
    v_fma_f32 v118, v187, v102, v118
    v_fma_f32 v119, v191, v103, v119
    v_fma_f32 v112, v192, v96, v112
    v_fma_f32 v113, v196, v97, v113
    v_fma_f32 v114, v193, v98, v114
    v_fma_f32 v115, v197, v99, v115
    v_fma_f32 v116, v194, v100, v116
    v_fma_f32 v117, v198, v101, v117
    v_fma_f32 v118, v195, v102, v118
    v_fma_f32 v119, v199, v103, v119
    v_cvt_pk_bf16_f32 v44, v112, v113
    v_cvt_pk_bf16_f32 v45, v114, v115
    v_cvt_pk_bf16_f32 v46, v116, v117
    v_cvt_pk_bf16_f32 v47, v118, v119
    s_cmp_eq_u32 s58, 4
    s_cselect_b64 exec, s[60:61], -1
    global_store_dword v17, v44, s[32:33] offset:0
    s_cmp_eq_u32 s58, 5
    s_cselect_b64 exec, s[60:61], -1
    global_store_dword v17, v45, s[32:33] offset:1024
    s_cmp_eq_u32 s58, 6
    s_cselect_b64 exec, s[60:61], -1
    global_store_dword v17, v46, s[32:33] offset:2048
    s_cmp_eq_u32 s58, 7
    s_cselect_b64 exec, s[60:61], -1
    global_store_dword v17, v47, s[32:33] offset:3072
    s_mov_b64 exec, -1
L_h_done:
L_exit:
L_end:
    s_endpgm
.section .rodata,"a"
.p2align 6
.amdhsa_kernel recurrent_scan__ssm_conv_s4__moe_arch_mod__prompt_kernel
  .amdhsa_next_free_vgpr 256
  .amdhsa_next_free_sgpr 102
  .amdhsa_accum_offset 256
  .amdhsa_group_segment_fixed_size 0
  .amdhsa_kernarg_size 136
  .amdhsa_user_sgpr_count 2
  .amdhsa_user_sgpr_kernarg_segment_ptr 1
  .amdhsa_system_sgpr_workgroup_id_x 1
.end_amdhsa_kernel
```
